```python
import torch

def _softmax(x, axis=-1):
    return torch.softmax(x, dim=axis)
def _gelu(x):
    return torch.nn.functional.gelu(x, approximate="tanh")
def _silu(x):
    return torch.nn.functional.silu(x)
def _sigmoid(x):
    return torch.sigmoid(x)
def _layernorm(x, axis=-1, eps=1e-5):
    m = x.mean(dim=axis, keepdim=True)
    v = x.var(dim=axis, keepdim=True, unbiased=False)
    return (x - m) / torch.sqrt(v + eps)
def _scatter_add(tgt, idx, src, axis=0):
    return tgt.clone().index_add_(axis, idx, src)
def _segment_sum(src, seg, n):
    out = torch.zeros((n,) + src.shape[1:], dtype=src.dtype)
    return out.index_add_(0, seg, src)
def _pad(x, pw):
    flat = tuple(v for pair in reversed(pw) for v in pair)
    return torch.nn.functional.pad(x, flat)

kernel_name = 'sequential_preLN__ssm_conv_s4__dense_activation_relu__prompt'

def setup_inputs():

    _w = (lambda a: (lambda t: t.to(torch.bfloat16) if t.is_floating_point() else t)(torch.as_tensor(a)))
    def _A_setup():
        B, L, D, N = 1, 2048, 512, 128
        A_re = -(lambda _x: torch.exp(torch.as_tensor(_x)))((lambda *s: torch.randn(*s, dtype=torch.bfloat16) * 6.4)(D, N))
        A_im = torch.pi * (lambda *s: torch.randn(*s, dtype=torch.bfloat16) * 0.05)(D, N)
        B_re = (lambda *s: torch.randn(*s, dtype=torch.bfloat16) * 0.05)(D, N)
        B_im = (lambda *s: torch.randn(*s, dtype=torch.bfloat16) * 0.05)(D, N)
        C_re = (lambda *s: torch.randn(*s, dtype=torch.bfloat16) * 0.05)(D, N)
        C_im = (lambda *s: torch.randn(*s, dtype=torch.bfloat16) * 0.05)(D, N)
        log_dt = (lambda *s: torch.randn(*s, dtype=torch.bfloat16) * 0.05)(D) * 0.5 - 4.0
        Dskip = (lambda *s: torch.randn(*s, dtype=torch.bfloat16) * 0.05)(D)
        return {
            "u": _w((lambda *s: torch.randn(*s, dtype=torch.bfloat16) * 0.05)(B, L, D)),
            "A_re": _w(A_re),
            "A_im": _w(A_im),
            "B_re": _w(B_re),
            "B_im": _w(B_im),
            "C_re": _w(C_re),
            "C_im": _w(C_im),
            "log_dt": _w(log_dt),
            "Dskip": _w(Dskip),
        }
    _A_in = _A_setup()

    def _B_setup():
        B, S, D, Dff = 1, 2048, 512, 1792
        return {
            "x": _w((lambda *s: torch.randn(*s, dtype=torch.bfloat16) * 0.05)(B, S, D)),
            "w1": _w((lambda *s: torch.randn(*s, dtype=torch.bfloat16) * 0.05)(D, Dff)),
            "w2": _w((lambda *s: torch.randn(*s, dtype=torch.bfloat16) * 0.05)(Dff, D)),
        }
    _B_in = _B_setup()

    return {
        "A_u": _A_in["u"],
        "A_A_re": _A_in["A_re"],
        "A_A_im": _A_in["A_im"],
        "A_B_re": _A_in["B_re"],
        "A_B_im": _A_in["B_im"],
        "A_C_re": _A_in["C_re"],
        "A_C_im": _A_in["C_im"],
        "A_log_dt": _A_in["log_dt"],
        "A_Dskip": _A_in["Dskip"],
        "B_x": _B_in["x"],
        "B_w1": _B_in["w1"],
        "B_w2": _B_in["w2"],
    }

def reference(A_u, A_A_re, A_A_im, A_B_re, A_B_im, A_C_re, A_C_im, A_log_dt, A_Dskip, B_x, B_w1, B_w2):
    def _A_ref(u, A_re, A_im, B_re, B_im, C_re, C_im, log_dt, Dskip):
        Bsz, L, D = u.shape
        dt = torch.exp(log_dt)[:, None]
        A = A_re + 1j * A_im
        Bc = B_re + 1j * B_im
        Cc = C_re + 1j * C_im
        logdA = dt * A
        dB = dt * Bc
        l = (lambda x, dt: x.to(dt))(torch.arange(L), A_re.dtype)
        P = torch.exp(logdA[:, :, None] * l[None, None, :])
        K = torch.einsum("dn,dnl,dn->dl", Cc, P, dB).real
        L2 = 2 * L
        Kp = _pad(K, ((0, 0), (0, L)))
        up = (lambda x, *d: x.permute(*d))(u, 0, 2, 1)
        up = _pad(up, ((0, 0), (0, 0), (0, L)))
        Kf = (lambda x, axes=(-2,-1): torch.fft.rfft2(x.float(), dim=axes))(Kp[:, None, :], axes=(-2, -1))
        Uf = (lambda x, axes=(-2,-1): torch.fft.rfft2(x.float(), dim=axes))(up[:, :, None, :], axes=(-2, -1))
        Yf = Uf * Kf[None, :, :, :]
        y = (lambda x, s, axes=(-2,-1): torch.fft.irfft2(x, s=s, dim=axes).to(torch.bfloat16))(Yf, (1, L2), axes=(-2, -1))[:, :, 0, :L]
        y = (lambda x, *d: x.permute(*d))(y, 0, 2, 1) + u * Dskip[None, None, :]
        return y

    def _B_ref(x, w1, w2):
        h = torch.einsum("bsd,df->bsf", x, w1)
        zero = torch.zeros_like(h)
        h = torch.maximum(h, zero)
        return torch.einsum("bsf,fd->bsd", h, w2)

    x = A_u
    h = x + _A_ref(_layernorm(x, axis=-1), A_A_re, A_A_im, A_B_re, A_B_im, A_C_re, A_C_im, A_log_dt, A_Dskip)
    h2 = h + _B_ref(_layernorm(h, axis=-1), B_w1, B_w2)
    return h2
```

```asm
; @launch grid=(256,1,1) block=(256,1,1) lds=163840
.amdgcn_target "amdgcn-amd-amdhsa--gfx950"
.text
.globl sequential_preLN__ssm_conv_s4__dense_activation_relu__prompt_kernel
.p2align 8
.type sequential_preLN__ssm_conv_s4__dense_activation_relu__prompt_kernel,@function
sequential_preLN__ssm_conv_s4__dense_activation_relu__prompt_kernel:
Lstart:
    s_load_dwordx16 s[72:87], s[0:1], 0
    s_load_dwordx2 s[44:45], s[0:1], 112
    s_load_dwordx2 s[88:89], s[0:1], 64
    s_load_dwordx2 s[52:53], s[0:1], 80
    s_getpc_b64 s[98:99]
    s_cmp_ge_u32 s2, 256
    s_cbranch_scc1 Lend
    s_lshl_b32 s10, s2, 10
    s_and_b32 s12, s10, 0x6000
    v_lshrrev_b32 v51, 2, v0
    v_lshl_add_u32 v220, v51, 7, s12
    v_min_u32 v220, Lcodeend-Lstart-64, v220
    global_load_dword v221, v220, s[98:99]
    s_and_b32 s11, s2, 7
    s_lshl_b32 s11, s11, 18
    s_and_b32 s12, s10, 0x3e000
    s_add_u32 s11, s11, s12
    v_and_b32 v54, 3, v0
    v_lshl_add_u32 v50, v54, 11, s11
    v_lshl_add_u32 v50, v51, 4, v50
    s_lshr_b32 s10, s11, 4
    v_lshl_add_u32 v53, v0, 1, s10
    v_mov_b32 v55, 13697024
    s_lshr_b32 s10, s10, 7
    v_mov_b32 v56, s10
    s_waitcnt lgkmcnt(0)
    global_load_dwordx2 v[234:235], v55, s[44:45]
    global_load_dwordx4 v[224:227], v50, s[72:73] offset:0
    global_load_dwordx4 v[228:231], v50, s[72:73] offset:1024
    global_load_dword v136, v56, s[86:87]
    global_load_ushort v40, v53, s[74:75]
    global_load_ushort v41, v53, s[76:77]
    global_load_ushort v42, v53, s[78:79]
    global_load_ushort v43, v53, s[80:81]
    global_load_ushort v44, v53, s[82:83]
    global_load_ushort v45, v53, s[84:85]
    global_load_dword v118, v56, s[88:89]
    s_load_dwordx2 s[56:57], s[0:1], 88
    s_load_dwordx2 s[60:61], s[0:1], 96
    s_load_dwordx2 s[64:65], s[0:1], 112
    v_readfirstlane_b32 s3, v0
    s_nop 0
    v_bfe_u32 v57, v0, 2, 4
    v_mul_u32_u24 v124, 3584, v57
    v_lshl_add_u32 v124, v54, 4, v124
    v_add_u32 v125, 56320, v124
    v_add_u32 v126, 112640, v124
    v_add_u32 v127, 168960, v124
    s_mov_b32 s54, 1835008
    s_mov_b32 s55, 0x20000
    s_lshr_b32 s3, s3, 6
    s_lshl_b32 s42, s10, 5
    s_add_u32 s42, s42, 4194304
    s_add_u32 s43, s42, 0x100000
    s_lshr_b32 s51, s11, 7
    s_lshl_b32 s49, s10, 12
    s_lshr_b32 s72, s2, 5
    s_bfe_u32 s73, s2, 0x20003
    s_and_b32 s74, s2, 1
    s_lshl1_add_u32 s75, s73, s72
    s_min_u32 s76, s72, 6
    s_mul_i32 s77, s74, 7
    s_add_u32 s76, s76, s77
    s_lshl2_add_u32 s76, s76, s3
    s_lshl_b32 s77, s76, 6
    s_and_b32 s78, s2, 6
    s_lshl1_add_u32 s78, s78, s73
    s_lshl1_add_u32 s78, s78, s74
    s_lshl_b32 s38, s3, 14
    s_add_u32 s39, s38, 4096
    s_add_u32 s40, s38, 8192
    s_add_u32 s41, s38, 12288
    v_xor_b32 v123, s3, v0
    v_add_u32 v123, s75, v123
    v_and_b32 v123, 7, v123
    s_and_b32 s79, s3, 2
    v_xor_b32 v212, s79, v0
    v_add_u32 v212, s75, v212
    v_and_b32_e64 v212, 7, v212
    v_mul_u32_u24 v212, 229376, v212
    v_add_u32 v212, s77, v212
    v_lshrrev_b32 v60, 3, v0
    v_lshlrev_b32 v2, 15, v60
    v_and_b32 v55, 7, v0
    v_lshl_add_u32 v2, v55, 4, v2
    v_mov_b32 v68, -1
    v_mov_b32 v69, -1
    v_mov_b32 v70, -1
    v_mov_b32 v71, -1
    s_mov_b32 s46, 0x10000000
    s_mov_b32 s47, 0x20000
    buffer_store_dwordx4 v[68:71], v2, s[44:47], s42 offen sc1
    buffer_store_dwordx4 v[68:71], v2, s[44:47], s43 offen sc1
    v_lshrrev_b32 v52, 6, v0
    v_and_b32 v12, 63, v0
    v_lshlrev_b32 v1, 4, v12
    v_lshrrev_b32 v58, 4, v12
    v_lshrrev_b32 v56, 5, v12
    v_and_b32 v59, 1, v0
    v_mul_u32_u24 v46, 4352, v52
    v_add_u32 v46, 131072, v46
    v_lshl_add_u32 v47, v57, 4, v46
    v_add_u32_e64 v46, v46, v1
    v_bfe_u32 v48, v0, 1, 1
    v_mul_u32_u24 v48, 2176, v48
    v_add_u32_e64 v47, v47, v48
    v_lshl_add_u32 v47, v59, 3, v47
    v_lshrrev_b32 v60, 3, v0
    v_lshlrev_b32 v2, 15, v60
    v_and_b32_e64 v55, 7, v0
    v_lshl_add_u32 v2, v55, 4, v2
    v_mov_b32 v68, -1
    v_mov_b32 v69, -1
    v_mov_b32 v70, -1
    v_mov_b32 v71, -1
    s_mov_b32 s46, 0x10000000
    s_mov_b32 s47, 0x20000
    s_mov_b32 s58, 1835008
    s_mov_b32 s59, 0x20000
    s_mov_b32 s62, 0x200000
    s_mov_b32 s63, 0x20000
    s_mov_b32 s67, 0x20000
    s_mov_b32 s70, 0xffff0000
    s_mov_b32 s71, 0xffff0000
    s_mov_b32 s90, 0x3f803f80
    s_mov_b32 s98, 0xaaaaaaaa
    s_mov_b32 s99, 0xaaaaaaaa
    s_mov_b32 s96, 0x05040100
    s_mov_b32 s91, 0
    s_nop 0
    s_mul_i32 s79, s51, 255
    v_lshl_add_u32 v208, v0, 4, s79
    v_add_u32 v209, 4096, v208
    v_add_u32 v210, 8192, v208
    v_add_u32 v211, 12288, v208
    v_lshlrev_b32_e64 v141, 14, v51
    v_lshl_add_u32 v141, v54, 4, v141
    s_bfe_u32 s79, s10, 0x20002
    s_lshl_b32 s79, s79, 12
    s_lshr_b32 s49, s10, 4
    s_lshl_b32 s49, s49, 6
    s_add_u32 s49, s49, s79
    v_lshrrev_b32 v133, 4, v0
    v_lshlrev_b32 v133, 4, v133
    v_lshl_add_u32 v133, v54, 8, v133
    v_add_u32 v133, 156672, v133
    v_add_u32 v134, 156672, v1
    v_lshlrev_b32 v135, 4, v58
    v_lshlrev_b32 v3, 8, v56
    v_bfe_u32 v55, v12, 2, 2
    v_lshl_add_u32 v3, v55, 6, v3
    v_and_b32_e64 v57, 1, v58
    v_lshl_add_u32 v3, v57, 5, v3
    v_lshl_add_u32 v3, v54, 3, v3
    v_lshl_add_u32 v13, v52, 14, v3
    v_mov_b32 v4, v13
    v_and_b32 v108, 64, v0
    v_lshl_add_u32 v108, v108, 6, v13
    v_xor_b32 v109, 4096, v108
    v_xor_b32 v5, 16384, v13
    v_xor_b32 v6, 32768, v13
    v_xor_b32 v7, 49152, v13
    v_add_u32 v139, 65536, v13
    v_lshl_add_u32 v140, v52, 12, v3
    v_add_u32 v140, 131072, v140
    v_xor_b32 v144, v57, v59
    v_add_u32 v144, -1, v144
    v_and_b32 v144, s90, v144
    v_mov_b32 v145, v144
    v_mov_b32 v146, v144
    v_mov_b32 v147, v144
    v_lshl_add_u32 v49, v52, 11, v1
    v_add_u32 v48, 148480, v49
    v_xor_b32 v49, 2048, v49
    v_add_u32 v49, 148480, v49
    v_lshrrev_b32 v62, 7, v0
    v_and_b32 v63, 1, v52
    v_mul_u32_u24 v64, 16640, v62
    v_and_b32 v132, 127, v0
    v_lshl_add_u32 v132, v132, 5, v64
    v_add_u32 v132, 65576, v132
    v_lshl_add_u32 v64, v63, 8, v64
    v_mul_u32_u24 v61, 4160, v54
    v_add_u32_e64 v55, v55, v58
    v_lshl_add_u32 v61, v55, 4, v61
    v_add_u32_e64 v14, v61, v64
    v_add_u32 v14, 65536, v14
    v_and_b32_e64 v61, 15, v12
    v_lshl_add_u32 v61, v61, 4, v64
    v_add_u32 v61, 78064, v61
    v_lshl_add_u32 v130, v56, 9, v61
    v_lshl_add_u32 v130, v57, 3, v130
    v_lshl_add_u32 v131, v58, 9, v61
    v_mul_u32_u24 v64, 9472, v62
    v_lshl_add_u32 v64, v63, 8, v64
    v_mul_u32_u24 v61, 4640, v59
    v_lshl_add_u32 v61, v58, 4, v61
    v_bfe_u32 v62, v12, 1, 3
    v_lshlrev_b32 v62, 6, v62
    v_sub_u32 v61, v61, v62
    v_add_u32_e64 v61, v61, v64
    v_add_u32 v15, 99280, v61
    v_lshlrev_b32_e64 v110, 4, v0
    v_mul_u32_u24 v61, 9472, v63
    v_mul_u32_u24 v62, 4640, v56
    v_and_b32 v63, 31, v0
    v_lshlrev_b32 v64, 4, v63
    v_add3_u32 v61, v61, v62, v64
    v_add_u32 v61, 102912, v61
    v_lshrrev_b32_e64 v63, 2, v63
    v_mul_u32_u24 v63, 4160, v63
    v_min_u32_e64 v64, 2, v54
    v_lshl_add_u32 v63, v64, 4, v63
    v_add_u32 v63, 65536, v63
    v_cmp_gt_u32 vcc, 128, v0
    v_mov_b32 v64, 0
    v_mov_b32 v65, 0
    v_cndmask_b32 v61, v63, v61, vcc
    v_mov_b32 v66, 0
    v_mov_b32_e64 v67, 0
    ds_write_b128 v61, v[64:67]
    v_lshl_add_u32 v61, v56, 2, v54
    v_lshl_add_u32 v61, v52, 1, v61
    v_and_b32_e64 v61, 7, v61
    v_bfe_u32 v62, v12, 2, 3
    v_lshlrev_b32_e64 v62, 10, v62
    v_lshl_add_u32 v8, v61, 4, v62
    v_add_u32 v9, 7168, v8
    v_add_u32 v10, 14336, v8
    v_add_u32 v11, 21504, v8
    v_lshlrev_b32_e64 v113, 2, v0
    v_sub_u32 v111, 99844, v113
    v_add_u32 v112, 4648, v111
    v_add_u32 v129, 147456, v113
    v_add_u32 v113, 117760, v113
    v_lshlrev_b32_e64 v61, 4, v57
    v_lshl_or_b32 v61, v56, 7, v61
    v_xor_b32_e64 v114, v61, v1
    v_lshl_add_u32 v114, v52, 12, v114
    v_add_u32 v114, 131072, v114
    v_lshlrev_b32_e64 v115, 10, v52
    v_lshl_add_u32 v115, v54, 8, v115
    v_and_b32_e64 v61, 7, v60
    v_lshl_add_u32 v115, v61, 5, v115
    v_lshlrev_b32 v61, 4, v59
    v_and_b32 v62, 2, v0
    v_lshl_or_b32 v61, v62, 6, v61
    v_xor_b32_e64 v115, v61, v115
    v_bfe_u32 v223, v0, 2, 1
    v_lshl_add_u32 v115, v223, 13, v115
    v_add_u32 v115, 131072, v115
    v_xor_b32 v119, 16, v115
    v_lshlrev_b32 v61, 6, v60
    v_lshl_add_u32 v61, v54, 4, v61
    v_lshl_add_u32 v116, v223, 12, v61
    v_add_u32 v116, 117760, v116
    v_mul_u32_u24 v117, 9472, v223
    v_sub_u32_e64 v117, v117, v61
    v_add_u32 v117, 105504, v117
    v_lshlrev_b32_e64 v223, 4, v223
    v_lshl_add_u32 v128, v52, 14, v1
    v_lshlrev_b32_e64 v138, 2, v12
    v_add_u32 v138, 147456, v138
    v_lshrrev_b32 v137, 3, v0
    v_and_b32_e64 v137, 16, v137
    s_waitcnt lgkmcnt(0)
    s_mov_b32 s101, 0x07060302
    s_mov_b32 s97, 0
    s_waitcnt vmcnt(2)
    v_add_u32 v234, 1, v234
    v_mov_b32 v239, v235
    v_readfirstlane_b32 s68, v234
    v_readfirstlane_b32 s69, v235
    v_mov_b32 v232, v224
    v_mov_b32 v233, v228
    buffer_store_dwordx4 v[232:235], v208, s[44:47], s51 offen sc1
    v_mov_b32 v236, v225
    v_mov_b32 v237, v229
    v_mov_b32_e64 v238, v234
    buffer_store_dwordx4 v[236:239], v209, s[44:47], s51 offen sc1
    v_mov_b32 v240, v226
    v_mov_b32 v241, v230
    v_mov_b32 v242, v234
    v_mov_b32 v243, v235
    buffer_store_dwordx4 v[240:243], v210, s[44:47], s51 offen sc1
    v_mov_b32 v244, v227
    v_mov_b32 v245, v231
    v_mov_b32 v246, v234
    v_mov_b32 v247, v235
    buffer_store_dwordx4 v[244:247], v211, s[44:47], s51 offen sc1
    v_dot2_f32_bf16 v248, v224, s90, 0
    v_dot2_f32_bf16 v250, v224, v224, 0
    v_dot2_f32_bf16 v249, v228, s90, 0
    v_dot2_f32_bf16 v251, v228, v228, 0
    v_dot2_f32_bf16 v248, v225, s90, v248
    v_dot2_f32_bf16 v250, v225, v225, v250
    v_dot2_f32_bf16 v249, v229, s90, v249
    v_dot2_f32_bf16 v251, v229, v229, v251
    v_dot2_f32_bf16 v248, v226, s90, v248
    v_dot2_f32_bf16 v250, v226, v226, v250
    v_dot2_f32_bf16 v249, v230, s90, v249
    v_dot2_f32_bf16 v251, v230, v230, v251
    v_dot2_f32_bf16 v248, v227, s90, v248
    v_dot2_f32_bf16 v250, v227, v227, v250
    v_dot2_f32_bf16 v249, v231, s90, v249
    v_dot2_f32_bf16 v251, v231, v231, v251
    v_lshrrev_b32 v118, v223, v118
    v_lshlrev_b32 v118, 16, v118
    v_xor_b32_e64 v142, v234, v0
    v_add_f32_dpp v248, v248, v248 row_shr:4 row_mask:0xf bank_mask:0xf bound_ctrl:0
    v_add_f32_dpp v249, v249, v249 row_shr:4 row_mask:0xf bank_mask:0xf bound_ctrl:0
    v_add_f32_dpp v250, v250, v250 row_shr:4 row_mask:0xf bank_mask:0xf bound_ctrl:0
    v_add_f32_dpp v251, v251, v251 row_shr:4 row_mask:0xf bank_mask:0xf bound_ctrl:0
    v_add_f32_dpp v248, v248, v248 row_shr:8 row_mask:0xf bank_mask:0xf bound_ctrl:0
    v_add_f32_dpp v249, v249, v249 row_shr:8 row_mask:0xf bank_mask:0xf bound_ctrl:0
    v_add_f32_dpp v250, v250, v250 row_shr:8 row_mask:0xf bank_mask:0xf bound_ctrl:0
    v_add_f32_dpp v251, v251, v251 row_shr:8 row_mask:0xf bank_mask:0xf bound_ctrl:0
    s_mov_b32 exec_lo, 0xf000f000
    s_mov_b32 exec_hi, 0xf000f000
    ds_write_b128 v133, v[248:251]
    s_mov_b64 exec, -1
    v_and_b32 v142, 1, v142
    v_mul_u32_u24 v142, 0x10001, v142
    v_lshlrev_b32_e64 v142, 15, v142
    v_readlane_b32 s16, v212, 0
    v_readlane_b32 s17, v212, 1
    v_readlane_b32 s18, v212, 2
    v_readlane_b32 s19, v212, 3
    v_readlane_b32 s20, v212, 4
    v_readlane_b32 s21, v212, 5
    v_readlane_b32 s22, v212, 6
    v_readlane_b32 s23, v212, 7
    s_waitcnt vmcnt(4)
    s_waitcnt lgkmcnt(0)
    s_barrier
    s_cmp_lg_u32 s3, 0
    s_cbranch_scc1 Lnopub
    s_nop 0
    ds_read_b128 v[248:251], v134
    s_add_u32 s10, s51, 13631488
    s_mov_b32 s12, 0x3b000000
    s_mov_b32 s13, 0x3b000000
    v_mov_b32 v255, v234
    s_waitcnt lgkmcnt(0)
    v_add_f32_dpp v248, v248, v248 row_shr:1 row_mask:0xf bank_mask:0xf bound_ctrl:0
    v_add_f32_dpp v249, v249, v249 row_shr:1 row_mask:0xf bank_mask:0xf bound_ctrl:0
    v_add_f32_dpp v250, v250, v250 row_shr:1 row_mask:0xf bank_mask:0xf bound_ctrl:0
    v_add_f32_dpp v251, v251, v251 row_shr:1 row_mask:0xf bank_mask:0xf bound_ctrl:0
    v_add_f32_dpp v248, v248, v248 row_shr:2 row_mask:0xf bank_mask:0xf bound_ctrl:0
    v_add_f32_dpp v249, v249, v249 row_shr:2 row_mask:0xf bank_mask:0xf bound_ctrl:0
    v_add_f32_dpp v250, v250, v250 row_shr:2 row_mask:0xf bank_mask:0xf bound_ctrl:0
    v_add_f32_dpp v251, v251, v251 row_shr:2 row_mask:0xf bank_mask:0xf bound_ctrl:0
    v_add_f32_dpp v248, v248, v248 row_shr:4 row_mask:0xf bank_mask:0xf bound_ctrl:0
    v_add_f32_dpp v249, v249, v249 row_shr:4 row_mask:0xf bank_mask:0xf bound_ctrl:0
    v_add_f32_dpp v250, v250, v250 row_shr:4 row_mask:0xf bank_mask:0xf bound_ctrl:0
    v_add_f32_dpp v251, v251, v251 row_shr:4 row_mask:0xf bank_mask:0xf bound_ctrl:0
    v_add_f32_dpp v248, v248, v248 row_shr:8 row_mask:0xf bank_mask:0xf bound_ctrl:0
    v_add_f32_dpp v249, v249, v249 row_shr:8 row_mask:0xf bank_mask:0xf bound_ctrl:0
    v_add_f32_dpp v250, v250, v250 row_shr:8 row_mask:0xf bank_mask:0xf bound_ctrl:0
    v_add_f32_dpp v251, v251, v251 row_shr:8 row_mask:0xf bank_mask:0xf bound_ctrl:0
    v_pk_mul_f32 v[248:249], v[248:249], s[12:13]
    v_pk_mul_f32 v[250:251], v[250:251], s[12:13]
    v_pk_fma_f32 v[250:251], v[248:249], v[248:249], v[250:251] neg_lo:[1,0,0] neg_hi:[1,0,0]
    v_cvt_pk_bf16_f32 v254, v248, v249
    v_cvt_pk_bf16_f32 v248, v250, v251
    v_pk_max_i16 v248, v248, 0
    v_and_b32 v251, s70, v248
    v_lshlrev_b32 v250, 16, v248
    v_add_f32 v250, 0x3727c5ac, v250
    v_add_f32 v251, 0x3727c5ac, v251
    v_cvt_pk_bf16_f32 v248, v250, v251
    v_and_b32 v251, s70, v248
    v_lshlrev_b32 v250, 16, v248
    v_sqrt_f32 v250, v250
    v_sqrt_f32_e64 v251, v251
    s_nop 0
    v_cvt_pk_bf16_f32 v248, v250, v251
    v_and_b32 v251, s70, v248
    v_lshlrev_b32 v250, 16, v248
    v_rcp_f32 v252, v250
    v_rcp_f32 v253, v251
    s_mov_b32 exec_lo, 0x80008000
    s_mov_b32 exec_hi, 0x80008000
    buffer_store_dwordx4 v[252:255], v135, s[44:47], s10 offen sc1
    s_mov_b64 exec, -1
Lnopub:
    v_lshrrev_b32 v136, v137, v136
    v_lshlrev_b32_e64 v136, 16, v136
    v_mul_f32 v136, 0x3fb8aa3b, v136
    v_exp_f32 v64, v136
    v_lshlrev_b32 v40, 16, v40
    v_lshlrev_b32 v41, 16, v41
    v_lshlrev_b32 v42, 16, v42
    v_lshlrev_b32 v43, 16, v43
    v_lshlrev_b32 v44, 16, v44
    v_lshlrev_b32_e64 v45, 16, v45
    s_mov_b32 m0, s38
    s_nop 0
    buffer_load_dwordx4 v124, s[52:55], s16 offen offset:0 lds
    v_cvt_pk_bf16_f32 v64, v64, v64
    v_lshlrev_b32_e64 v64, 16, v64
    s_mov_b32 s10, 0x3fb8aa3b
    s_mov_b32 s11, 0x3e22f983
    s_nop 0
    v_pk_mul_f32 v[40:41], v[40:41], v[64:65] op_sel_hi:[1,0]
    v_pk_mul_f32 v[42:43], v[42:43], v[64:65] op_sel_hi:[1,0]
    v_pk_mul_f32 v[40:41], v[40:41], s[10:11]
    v_pk_mul_f32 v[52:53], v[44:45], v[42:43] op_sel:[0,0] op_sel_hi:[1,0] neg_hi:[1,0]
    v_pk_fma_f32 v[52:53], v[44:45], v[42:43], v[52:53] op_sel:[1,1,0] op_sel_hi:[0,1,1] neg_lo:[1,0,0] neg_hi:[1,0,0]
    v_mul_f32 v16, 0x41000000, v40
    v_mul_f32 v17, 0x41000000, v41
    v_mul_f32 v18, 0x43000000, v40
    buffer_load_dwordx4 v125, s[52:55], s16 offen offset:1024 lds
    v_mul_f32 v19, 0x43000000, v41
    v_fract_f32 v17, v17
    v_fract_f32 v19, v19
    v_fract_f32 v41, v41
    v_cos_f32 v72, v17
    v_sin_f32 v73, v17
    v_exp_f32 v16, v16
    v_cos_f32_e64 v74, v19
    buffer_load_dwordx4 v126, s[52:55], s16 offen offset:2048 lds
    v_sin_f32 v75, v19
    v_exp_f32 v18, v18
    v_cos_f32 v76, v41
    v_sin_f32 v77, v41
    v_exp_f32_e64 v40, v40
    v_pk_mul_f32 v[72:73], v[72:73], v[16:17] op_sel_hi:[1,0]
    v_pk_mul_f32 v[74:75], v[74:75], v[18:19] op_sel_hi:[1,0]
    buffer_load_dwordx4 v127, s[52:55], s16 offen offset:3072 lds
    v_pk_mul_f32 v[76:77], v[76:77], v[40:41] op_sel_hi:[1,0]
    v_pk_mul_f32 v[54:55], v[52:53], v[74:75] op_sel:[0,0] op_sel_hi:[1,0]
    v_pk_fma_f32 v[54:55], v[52:53], v[74:75], v[54:55] op_sel:[1,1,0] op_sel_hi:[0,1,1] neg_hi:[1,0,0]
    v_pk_mul_f32 v[78:79], v[72:73], v[72:73] op_sel:[0,0] op_sel_hi:[1,0]
    v_pk_fma_f32 v[78:79], v[72:73], v[72:73], v[78:79] op_sel:[1,1,0] op_sel_hi:[0,1,1] neg_lo:[1,0,0]
    s_bitcmp1_b32 s3, 0
    s_cselect_b64 vcc, -1, 0
    v_cndmask_b32 v16, v52, v54, vcc
    v_cndmask_b32 v17, v53, v55, vcc
    v_cndmask_b32 v44, v54, v52, vcc
    v_cndmask_b32 v45, v55, v53, vcc
    v_pk_mul_f32 v[18:19], v[16:17], v[72:73] op_sel:[0,0] op_sel_hi:[1,0]
    s_mov_b32 m0, s39
    s_nop 0
    buffer_load_dwordx4 v124, s[52:55], s17 offen offset:0 lds
    v_pk_fma_f32 v[18:19], v[16:17], v[72:73], v[18:19] op_sel:[1,1,0] op_sel_hi:[0,1,1] neg_hi:[1,0,0]
    v_pk_mul_f32 v[20:21], v[16:17], v[78:79] op_sel:[0,0] op_sel_hi:[1,0]
    v_pk_mul_f32 v[22:23], v[18:19], v[78:79] op_sel:[0,0] op_sel_hi:[1,0]
    v_pk_fma_f32 v[20:21], v[16:17], v[78:79], v[20:21] op_sel:[1,1,0] op_sel_hi:[0,1,1] neg_hi:[1,0,0]
    v_pk_fma_f32 v[22:23], v[18:19], v[78:79], v[22:23] op_sel:[1,1,0] op_sel_hi:[0,1,1] neg_hi:[1,0,0]
    v_pk_mul_f32 v[24:25], v[20:21], v[78:79] op_sel:[0,0] op_sel_hi:[1,0]
    v_pk_mul_f32 v[26:27], v[22:23], v[78:79] op_sel:[0,0] op_sel_hi:[1,0]
    v_pk_fma_f32 v[24:25], v[20:21], v[78:79], v[24:25] op_sel:[1,1,0] op_sel_hi:[0,1,1] neg_hi:[1,0,0]
    v_pk_fma_f32 v[26:27], v[22:23], v[78:79], v[26:27] op_sel:[1,1,0] op_sel_hi:[0,1,1] neg_hi:[1,0,0]
    v_pk_mul_f32 v[28:29], v[24:25], v[78:79] op_sel:[0,0] op_sel_hi:[1,0]
    v_pk_mul_f32 v[30:31], v[26:27], v[78:79] op_sel:[0,0] op_sel_hi:[1,0]
    v_pk_fma_f32 v[28:29], v[24:25], v[78:79], v[28:29] op_sel:[1,1,0] op_sel_hi:[0,1,1] neg_hi:[1,0,0]
    buffer_load_dwordx4 v125, s[52:55], s17 offen offset:1024 lds
    v_pk_fma_f32 v[30:31], v[26:27], v[78:79], v[30:31] op_sel:[1,1,0] op_sel_hi:[0,1,1] neg_hi:[1,0,0]
    v_cvt_pk_bf16_f32 v56, v16, v18
    v_cvt_pk_bf16_f32 v57, v20, v22
    v_cvt_pk_bf16_f32 v58, v24, v26
    v_cvt_pk_bf16_f32 v59, v28, v30
    ds_write_b128 v46, v[56:59] offset:0
    buffer_load_dwordx4 v126, s[52:55], s17 offen offset:2048 lds
    v_cvt_pk_bf16_f32 v60, v17, v19
    v_cvt_pk_bf16_f32 v61, v21, v23
    v_cvt_pk_bf16_f32 v62, v25, v27
    v_cvt_pk_bf16_f32 v63, v29, v31
    ds_write_b128 v46, v[60:63] offset:1024
    v_pk_mul_f32 v[16:17], v[28:29], v[78:79] op_sel:[0,0] op_sel_hi:[1,0]
    buffer_load_dwordx4 v127, s[52:55], s17 offen offset:3072 lds
    v_pk_mul_f32 v[18:19], v[30:31], v[78:79] op_sel:[0,0] op_sel_hi:[1,0]
    v_pk_fma_f32 v[16:17], v[28:29], v[78:79], v[16:17] op_sel:[1,1,0] op_sel_hi:[0,1,1] neg_hi:[1,0,0]
    v_pk_fma_f32 v[18:19], v[30:31], v[78:79], v[18:19] op_sel:[1,1,0] op_sel_hi:[0,1,1] neg_hi:[1,0,0]
    v_pk_mul_f32 v[20:21], v[16:17], v[78:79] op_sel:[0,0] op_sel_hi:[1,0]
    v_pk_mul_f32 v[22:23], v[18:19], v[78:79] op_sel:[0,0] op_sel_hi:[1,0]
    v_pk_fma_f32 v[20:21], v[16:17], v[78:79], v[20:21] op_sel:[1,1,0] op_sel_hi:[0,1,1] neg_hi:[1,0,0]
    v_pk_fma_f32 v[22:23], v[18:19], v[78:79], v[22:23] op_sel:[1,1,0] op_sel_hi:[0,1,1] neg_hi:[1,0,0]
    v_pk_mul_f32 v[24:25], v[20:21], v[78:79] op_sel:[0,0] op_sel_hi:[1,0]
    v_pk_mul_f32 v[26:27], v[22:23], v[78:79] op_sel:[0,0] op_sel_hi:[1,0]
    v_pk_fma_f32 v[24:25], v[20:21], v[78:79], v[24:25] op_sel:[1,1,0] op_sel_hi:[0,1,1] neg_hi:[1,0,0]
    v_pk_fma_f32 v[26:27], v[22:23], v[78:79], v[26:27] op_sel:[1,1,0] op_sel_hi:[0,1,1] neg_hi:[1,0,0]
    v_pk_mul_f32 v[28:29], v[24:25], v[78:79] op_sel:[0,0] op_sel_hi:[1,0]
    v_pk_mul_f32 v[30:31], v[26:27], v[78:79] op_sel:[0,0] op_sel_hi:[1,0]
    v_pk_fma_f32 v[28:29], v[24:25], v[78:79], v[28:29] op_sel:[1,1,0] op_sel_hi:[0,1,1] neg_hi:[1,0,0]
    v_pk_fma_f32 v[30:31], v[26:27], v[78:79], v[30:31] op_sel:[1,1,0] op_sel_hi:[0,1,1] neg_hi:[1,0,0]
    v_cvt_pk_bf16_f32 v100, v16, v18
    v_cvt_pk_bf16_f32 v101, v20, v22
    v_cvt_pk_bf16_f32 v102, v24, v26
    v_cvt_pk_bf16_f32 v103, v28, v30
    ds_write_b128 v46, v[100:103] offset:2176
    v_cvt_pk_bf16_f32 v104, v17, v19
    v_cvt_pk_bf16_f32 v105, v21, v23
    v_cvt_pk_bf16_f32 v106, v25, v27
    v_cvt_pk_bf16_f32 v107, v29, v31
    ds_write_b128 v46, v[104:107] offset:3200
    v_mov_b32 v16, v44
    v_mov_b32 v17, v45
    v_pk_mul_f32 v[18:19], v[16:17], v[72:73] op_sel:[0,0] op_sel_hi:[1,0]
    v_pk_fma_f32 v[18:19], v[16:17], v[72:73], v[18:19] op_sel:[1,1,0] op_sel_hi:[0,1,1] neg_hi:[1,0,0]
    v_pk_mul_f32 v[20:21], v[16:17], v[78:79] op_sel:[0,0] op_sel_hi:[1,0]
    v_pk_mul_f32 v[22:23], v[18:19], v[78:79] op_sel:[0,0] op_sel_hi:[1,0]
    v_pk_fma_f32 v[20:21], v[16:17], v[78:79], v[20:21] op_sel:[1,1,0] op_sel_hi:[0,1,1] neg_hi:[1,0,0]
    v_pk_fma_f32 v[22:23], v[18:19], v[78:79], v[22:23] op_sel:[1,1,0] op_sel_hi:[0,1,1] neg_hi:[1,0,0]
    ds_read_b64_tr_b16 a[160:161], v47 offset:0
    ds_read_b64_tr_b16 a[162:163], v47 offset:256
    v_pk_mul_f32 v[24:25], v[20:21], v[78:79] op_sel:[0,0] op_sel_hi:[1,0]
    v_pk_mul_f32 v[26:27], v[22:23], v[78:79] op_sel:[0,0] op_sel_hi:[1,0]
    v_pk_fma_f32 v[24:25], v[20:21], v[78:79], v[24:25] op_sel:[1,1,0] op_sel_hi:[0,1,1] neg_hi:[1,0,0]
    v_pk_fma_f32 v[26:27], v[22:23], v[78:79], v[26:27] op_sel:[1,1,0] op_sel_hi:[0,1,1] neg_hi:[1,0,0]
    ds_read_b64_tr_b16 a[164:165], v47 offset:512
    ds_read_b64_tr_b16 a[166:167], v47 offset:768
    v_pk_mul_f32 v[28:29], v[24:25], v[78:79] op_sel:[0,0] op_sel_hi:[1,0]
    v_pk_mul_f32 v[30:31], v[26:27], v[78:79] op_sel:[0,0] op_sel_hi:[1,0]
    v_pk_fma_f32 v[28:29], v[24:25], v[78:79], v[28:29] op_sel:[1,1,0] op_sel_hi:[0,1,1] neg_hi:[1,0,0]
    v_pk_fma_f32 v[30:31], v[26:27], v[78:79], v[30:31] op_sel:[1,1,0] op_sel_hi:[0,1,1] neg_hi:[1,0,0]
    ds_read_b64_tr_b16 a[168:169], v47 offset:1024
    ds_read_b64_tr_b16 a[170:171], v47 offset:1280
    v_cvt_pk_bf16_f32 v56, v16, v18
    v_cvt_pk_bf16_f32 v57, v20, v22
    v_cvt_pk_bf16_f32 v58, v24, v26
    v_cvt_pk_bf16_f32 v59, v28, v30
    ds_read_b64_tr_b16 a[172:173], v47 offset:1536
    ds_read_b64_tr_b16 a[174:175], v47 offset:1792
    ds_write_b128 v46, v[56:59] offset:0
    v_cvt_pk_bf16_f32 v60, v17, v19
    v_cvt_pk_bf16_f32 v61, v21, v23
    v_cvt_pk_bf16_f32 v62, v25, v27
    v_cvt_pk_bf16_f32 v63, v29, v31
    ds_write_b128 v46, v[60:63] offset:1024
    v_pk_mul_f32 v[16:17], v[28:29], v[78:79] op_sel:[0,0] op_sel_hi:[1,0]
    v_pk_mul_f32 v[18:19], v[30:31], v[78:79] op_sel:[0,0] op_sel_hi:[1,0]
    v_pk_fma_f32 v[16:17], v[28:29], v[78:79], v[16:17] op_sel:[1,1,0] op_sel_hi:[0,1,1] neg_hi:[1,0,0]
    v_pk_fma_f32 v[18:19], v[30:31], v[78:79], v[18:19] op_sel:[1,1,0] op_sel_hi:[0,1,1] neg_hi:[1,0,0]
    v_pk_mul_f32 v[20:21], v[16:17], v[78:79] op_sel:[0,0] op_sel_hi:[1,0]
    v_pk_mul_f32 v[22:23], v[18:19], v[78:79] op_sel:[0,0] op_sel_hi:[1,0]
    v_pk_fma_f32 v[20:21], v[16:17], v[78:79], v[20:21] op_sel:[1,1,0] op_sel_hi:[0,1,1] neg_hi:[1,0,0]
    v_pk_fma_f32 v[22:23], v[18:19], v[78:79], v[22:23] op_sel:[1,1,0] op_sel_hi:[0,1,1] neg_hi:[1,0,0]
    v_pk_mul_f32 v[24:25], v[20:21], v[78:79] op_sel:[0,0] op_sel_hi:[1,0]
    v_pk_mul_f32 v[26:27], v[22:23], v[78:79] op_sel:[0,0] op_sel_hi:[1,0]
    v_pk_fma_f32 v[24:25], v[20:21], v[78:79], v[24:25] op_sel:[1,1,0] op_sel_hi:[0,1,1] neg_hi:[1,0,0]
    v_pk_fma_f32 v[26:27], v[22:23], v[78:79], v[26:27] op_sel:[1,1,0] op_sel_hi:[0,1,1] neg_hi:[1,0,0]
    v_pk_mul_f32 v[28:29], v[24:25], v[78:79] op_sel:[0,0] op_sel_hi:[1,0]
    v_pk_mul_f32 v[30:31], v[26:27], v[78:79] op_sel:[0,0] op_sel_hi:[1,0]
    v_pk_fma_f32 v[28:29], v[24:25], v[78:79], v[28:29] op_sel:[1,1,0] op_sel_hi:[0,1,1] neg_hi:[1,0,0]
    v_pk_fma_f32 v[30:31], v[26:27], v[78:79], v[30:31] op_sel:[1,1,0] op_sel_hi:[0,1,1] neg_hi:[1,0,0]
    v_cvt_pk_bf16_f32 v100, v16, v18
    v_cvt_pk_bf16_f32 v101, v20, v22
    v_cvt_pk_bf16_f32 v102, v24, v26
    v_cvt_pk_bf16_f32 v103, v28, v30
    ds_write_b128 v46, v[100:103] offset:2176
    v_cvt_pk_bf16_f32 v104, v17, v19
    v_cvt_pk_bf16_f32 v105, v21, v23
    v_cvt_pk_bf16_f32 v106, v25, v27
    v_cvt_pk_bf16_f32 v107, v29, v31
    ds_write_b128 v46, v[104:107] offset:3200
    v_pk_mul_f32 v[80:81], v[76:77], v[76:77] op_sel:[0,0] op_sel_hi:[1,0]
    v_pk_mul_f32 v[82:83], v[74:75], v[74:75] op_sel:[0,0] op_sel_hi:[1,0]
    v_pk_fma_f32 v[80:81], v[76:77], v[76:77], v[80:81] op_sel:[1,1,0] op_sel_hi:[0,1,1] neg_lo:[1,0,0]
    v_pk_fma_f32 v[82:83], v[74:75], v[74:75], v[82:83] op_sel:[1,1,0] op_sel_hi:[0,1,1] neg_lo:[1,0,0]
    ds_read_b64_tr_b16 a[176:177], v47 offset:0
    ds_read_b64_tr_b16 a[178:179], v47 offset:256
    v_pk_mul_f32 v[84:85], v[80:81], v[76:77] op_sel:[0,0] op_sel_hi:[1,0]
    v_pk_mul_f32 v[86:87], v[80:81], v[80:81] op_sel:[0,0] op_sel_hi:[1,0]
    v_pk_mul_f32 v[88:89], v[82:83], v[82:83] op_sel:[0,0] op_sel_hi:[1,0]
    v_pk_fma_f32 v[84:85], v[80:81], v[76:77], v[84:85] op_sel:[1,1,0] op_sel_hi:[0,1,1] neg_lo:[1,0,0]
    v_pk_fma_f32 v[86:87], v[80:81], v[80:81], v[86:87] op_sel:[1,1,0] op_sel_hi:[0,1,1] neg_lo:[1,0,0]
    v_pk_fma_f32 v[88:89], v[82:83], v[82:83], v[88:89] op_sel:[1,1,0] op_sel_hi:[0,1,1] neg_lo:[1,0,0]
    ds_read_b64_tr_b16 a[180:181], v47 offset:512
    ds_read_b64_tr_b16 a[182:183], v47 offset:768
    ds_read_b64_tr_b16 a[184:185], v47 offset:1024
    v_pk_mul_f32 v[90:91], v[86:87], v[76:77] op_sel:[0,0] op_sel_hi:[1,0]
    v_pk_mul_f32 v[92:93], v[86:87], v[80:81] op_sel:[0,0] op_sel_hi:[1,0]
    v_pk_mul_f32 v[94:95], v[86:87], v[84:85] op_sel:[0,0] op_sel_hi:[1,0]
    v_pk_fma_f32 v[90:91], v[86:87], v[76:77], v[90:91] op_sel:[1,1,0] op_sel_hi:[0,1,1] neg_lo:[1,0,0]
    v_pk_fma_f32 v[92:93], v[86:87], v[80:81], v[92:93] op_sel:[1,1,0] op_sel_hi:[0,1,1] neg_lo:[1,0,0]
    v_pk_fma_f32 v[94:95], v[86:87], v[84:85], v[94:95] op_sel:[1,1,0] op_sel_hi:[0,1,1] neg_lo:[1,0,0]
    ds_read_b64_tr_b16 a[186:187], v47 offset:1280
    ds_read_b64_tr_b16 a[188:189], v47 offset:1536
    ds_read_b64_tr_b16 a[190:191], v47 offset:1792
    v_cvt_pk_bf16_f32 v56, 1.0, v76
    v_cvt_pk_bf16_f32 v57, v80, v84
    v_cvt_pk_bf16_f32 v58, v86, v90
    v_cvt_pk_bf16_f32 v59, v92, v94
    ds_write_b128 v46, v[56:59] offset:0
    v_cvt_pk_bf16_f32 v60, 0, v77
    v_cvt_pk_bf16_f32 v61, v81, v85
    v_cvt_pk_bf16_f32 v62, v87, v91
    v_cvt_pk_bf16_f32 v63, v93, v95
    ds_write_b128 v46, v[60:63] offset:1024
    v_pk_mul_f32 v[96:97], v[82:83], v[80:81] op_sel:[0,0] op_sel_hi:[1,0]
    v_pk_mul_f32 v[98:99], v[82:83], v[86:87] op_sel:[0,0] op_sel_hi:[1,0]
    v_pk_mul_f32 v[78:79], v[82:83], v[92:93] op_sel:[0,0] op_sel_hi:[1,0]
    v_pk_mul_f32 v[16:17], v[82:83], v[72:73] op_sel:[0,0] op_sel_hi:[1,0]
    v_pk_fma_f32 v[96:97], v[82:83], v[80:81], v[96:97] op_sel:[1,1,0] op_sel_hi:[0,1,1] neg_lo:[1,0,0]
    v_pk_fma_f32 v[98:99], v[82:83], v[86:87], v[98:99] op_sel:[1,1,0] op_sel_hi:[0,1,1] neg_lo:[1,0,0]
    v_pk_fma_f32 v[78:79], v[82:83], v[92:93], v[78:79] op_sel:[1,1,0] op_sel_hi:[0,1,1] neg_lo:[1,0,0]
    v_pk_fma_f32 v[16:17], v[82:83], v[72:73], v[16:17] op_sel:[1,1,0] op_sel_hi:[0,1,1] neg_lo:[1,0,0]
    v_cvt_pk_bf16_f32 v100, v82, v82
    v_cvt_pk_bf16_f32 v101, v96, v98
    v_cvt_pk_bf16_f32 v102, v98, v98
    v_cvt_pk_bf16_f32 v103, v78, v16
    ds_write_b128 v46, v[100:103] offset:2176
    v_cvt_pk_bf16_f32 v104, v83, v83
    v_cvt_pk_bf16_f32 v105, v97, v99
    s_mov_b32 m0, s40
    s_nop 0
    buffer_load_dwordx4 v124, s[52:55], s18 offen offset:0 lds
    v_cvt_pk_bf16_f32 v106, v99, v99
    v_cvt_pk_bf16_f32 v107, v79, v17
    ds_write_b128 v46, v[104:107] offset:3200
    v_pk_mul_f32 v[18:19], v[88:89], v[86:87] op_sel:[0,0] op_sel_hi:[1,0]
    v_pk_mul_f32 v[20:21], v[88:89], v[72:73] op_sel:[0,0] op_sel_hi:[1,0]
    v_pk_mul_f32 v[22:23], v[88:89], v[88:89] op_sel:[0,0] op_sel_hi:[1,0]
    v_pk_mul_f32 v[24:25], v[88:89], v[82:83] op_sel:[0,0] op_sel_hi:[1,0]
    v_pk_fma_f32 v[18:19], v[88:89], v[86:87], v[18:19] op_sel:[1,1,0] op_sel_hi:[0,1,1] neg_lo:[1,0,0]
    v_pk_fma_f32 v[20:21], v[88:89], v[72:73], v[20:21] op_sel:[1,1,0] op_sel_hi:[0,1,1] neg_lo:[1,0,0]
    v_pk_fma_f32 v[22:23], v[88:89], v[88:89], v[22:23] op_sel:[1,1,0] op_sel_hi:[0,1,1] neg_lo:[1,0,0]
    v_pk_fma_f32 v[24:25], v[88:89], v[82:83], v[24:25] op_sel:[1,1,0] op_sel_hi:[0,1,1] neg_lo:[1,0,0]
    ds_read_b64_tr_b16 a[192:193], v47 offset:0
    ds_read_b64_tr_b16 a[194:195], v47 offset:256
    ds_read_b64_tr_b16 a[196:197], v47 offset:512
    ds_read_b64_tr_b16 a[198:199], v47 offset:768
    v_pk_mul_f32 v[26:27], v[22:23], v[72:73] op_sel:[0,0] op_sel_hi:[1,0]
    v_pk_mul_f32 v[28:29], v[22:23], v[82:83] op_sel:[0,0] op_sel_hi:[1,0]
    v_pk_mul_f32 v[30:31], v[22:23], v[88:89] op_sel:[0,0] op_sel_hi:[1,0]
    v_pk_mul_f32 v[40:41], v[22:23], v[24:25] op_sel:[0,0] op_sel_hi:[1,0]
    v_pk_fma_f32 v[26:27], v[22:23], v[72:73], v[26:27] op_sel:[1,1,0] op_sel_hi:[0,1,1] neg_lo:[1,0,0]
    v_pk_fma_f32 v[28:29], v[22:23], v[82:83], v[28:29] op_sel:[1,1,0] op_sel_hi:[0,1,1] neg_lo:[1,0,0]
    v_pk_fma_f32 v[30:31], v[22:23], v[88:89], v[30:31] op_sel:[1,1,0] op_sel_hi:[0,1,1] neg_lo:[1,0,0]
    v_pk_fma_f32 v[40:41], v[22:23], v[24:25], v[40:41] op_sel:[1,1,0] op_sel_hi:[0,1,1] neg_lo:[1,0,0]
    ds_read_b64_tr_b16 a[200:201], v47 offset:1024
    ds_read_b64_tr_b16 a[202:203], v47 offset:1280
    ds_read_b64_tr_b16 a[204:205], v47 offset:1536
    ds_read_b64_tr_b16 a[206:207], v47 offset:1792
    v_pk_mul_f32 v[42:43], v[28:29], v[72:73] op_sel:[0,0] op_sel_hi:[1,0]
    v_pk_mul_f32 v[44:45], v[24:25], v[86:87] op_sel:[0,0] op_sel_hi:[1,0]
    v_pk_mul_f32 v[76:77], v[24:25], v[72:73] op_sel:[0,0] op_sel_hi:[1,0]
    buffer_load_dwordx4 v125, s[52:55], s18 offen offset:1024 lds
    v_pk_fma_f32 v[42:43], v[28:29], v[72:73], v[42:43] op_sel:[1,1,0] op_sel_hi:[0,1,1] neg_lo:[1,0,0]
    v_pk_fma_f32 v[44:45], v[24:25], v[86:87], v[44:45] op_sel:[1,1,0] op_sel_hi:[0,1,1] neg_lo:[1,0,0]
    v_pk_fma_f32 v[76:77], v[24:25], v[72:73], v[76:77] op_sel:[1,1,0] op_sel_hi:[0,1,1] neg_lo:[1,0,0]
    v_pk_mul_f32 v[84:85], v[30:31], v[72:73] op_sel:[0,0] op_sel_hi:[1,0]
    v_pk_mul_f32 v[90:91], v[40:41], v[72:73] op_sel:[0,0] op_sel_hi:[1,0]
    v_pk_fma_f32 v[84:85], v[30:31], v[72:73], v[84:85] op_sel:[1,1,0] op_sel_hi:[0,1,1] neg_lo:[1,0,0]
    v_pk_fma_f32 v[90:91], v[40:41], v[72:73], v[90:91] op_sel:[1,1,0] op_sel_hi:[0,1,1] neg_lo:[1,0,0]
    s_waitcnt lgkmcnt(0)
    v_cvt_pk_bf16_f32 v56, v88, v18
    v_cvt_pk_bf16_f32 v57, v22, v26
    v_mfma_f32_16x16x32_bf16 v[32:35], a[192:195], a[176:179], 0
    v_cvt_pk_bf16_f32 v58, v18, v20
    v_cvt_pk_bf16_f32 v59, v28, v42
    v_mfma_f32_16x16x32_bf16 v[152:155], a[192:195], a[160:163], 0
    ds_write_b128 v46, v[56:59] offset:0
    v_cvt_pk_bf16_f32 v60, v89, v19
    v_cvt_pk_bf16_f32 v61, v23, v27
    v_mfma_f32_16x16x32_bf16 v[32:35], a[196:199], a[180:183], v[32:35]
    v_cvt_pk_bf16_f32 v62, v19, v21
    v_cvt_pk_bf16_f32 v63, v29, v43
    v_mfma_f32_16x16x32_bf16 v[152:155], a[196:199], a[164:167], v[152:155]
    ds_write_b128 v46, v[60:63] offset:1024
    buffer_load_dwordx4 v126, s[52:55], s18 offen offset:2048 lds
    v_cvt_pk_bf16_f32 v100, v24, v44
    v_cvt_pk_bf16_f32 v101, v30, v84
    v_mfma_f32_16x16x32_bf16 v[32:35], a[200:203], a[184:187], v[32:35]
    v_cvt_pk_bf16_f32 v102, v44, v76
    v_cvt_pk_bf16_f32 v103, v40, v90
    v_mfma_f32_16x16x32_bf16 v[152:155], a[200:203], a[168:171], v[152:155]
    ds_write_b128 v46, v[100:103] offset:2176
    v_cvt_pk_bf16_f32 v104, v25, v45
    v_cvt_pk_bf16_f32 v105, v31, v85
    v_mfma_f32_16x16x32_bf16 v[32:35], a[204:207], a[188:191], v[32:35]
    v_cvt_pk_bf16_f32 v106, v45, v77
    v_cvt_pk_bf16_f32 v107, v41, v91
    v_mfma_f32_16x16x32_bf16 v[152:155], a[204:207], a[172:175], v[152:155]
    ds_write_b128 v46, v[104:107] offset:3200
    ds_read_b64_tr_b16 a[208:209], v47 offset:0
    ds_read_b64_tr_b16 a[210:211], v47 offset:256
    ds_read_b64_tr_b16 a[212:213], v47 offset:512
    ds_read_b64_tr_b16 a[214:215], v47 offset:768
    ds_read_b64_tr_b16 a[216:217], v47 offset:1024
    ds_read_b64_tr_b16 a[218:219], v47 offset:1280
    ds_read_b64_tr_b16 a[220:221], v47 offset:1536
    ds_read_b64_tr_b16 a[222:223], v47 offset:1792
    buffer_load_dwordx4 v127, s[52:55], s18 offen offset:3072 lds
    ds_write_b128 v48, v[32:35]
    s_cmp_ge_u32 s75, 7
    s_cselect_b32 s79, 7, 0
    s_sub_u32 s79, s75, s79
    v_cmp_lt_u32 vcc, 6, v12
    v_add_u32 v122, s79, v12
    v_mov_b32 v120, s74
    v_subrev_u32 v121, 7, v122
    v_cndmask_b32 v122, v122, v121, vcc
    v_xor_b32 v121, 1, v120
    v_cndmask_b32 v120, v121, v120, vcc
    v_subrev_u32 v121, 7, v122
    v_min_u32 v122, v122, v121
    s_mul_i32 s79, s3, 7
    v_mad_u32_u24 v122, v120, 28, v122
    v_add_u32 v122, s79, v122
    s_waitcnt lgkmcnt(1)
    v_mfma_f32_16x16x32_bf16 v[36:39], a[208:211], a[176:179], 0
    s_lshl_b32 s79, s72, 7
    v_lshl_add_u32 v120, v122, 15, s79
    v_mfma_f32_16x16x32_bf16 v[36:39], a[212:215], a[180:183], v[36:39]
    s_mul_i32 s80, s78, 114688
    s_add_u32 s80, s80, 6291456
    v_mfma_f32_16x16x32_bf16 v[36:39], a[216:219], a[184:187], v[36:39]
    v_lshl_add_u32 v122, v122, 11, s80
    s_lshl_b32 s48, s3, 12
    v_mfma_f32_16x16x32_bf16 v[36:39], a[220:223], a[188:191], v[36:39]
    s_add_u32 s48, s48, 131072
    v_readlane_b32 s24, v120, 0
    v_mfma_f32_16x16x32_bf16 v[156:159], a[208:211], a[160:163], 0
    s_mov_b32 m0, s41
    s_nop 0
    buffer_load_dwordx4 v124, s[52:55], s19 offen offset:0 lds
    v_mfma_f32_16x16x32_bf16 v[156:159], a[212:215], a[164:167], v[156:159]
    v_readlane_b32 s25, v120, 1
    v_readlane_b32 s26, v120, 2
    v_mfma_f32_16x16x32_bf16 v[156:159], a[216:219], a[168:171], v[156:159]
    v_readlane_b32 s27, v120, 3
    v_readlane_b32 s28, v120, 4
    v_mfma_f32_16x16x32_bf16 v[156:159], a[220:223], a[172:175], v[156:159]
    v_readlane_b32 s29, v120, 5
    v_readlane_b32 s30, v120, 6
    s_nop 3
    ds_write_b128 v48, v[36:39] offset:1024
    v_readlane_b32 s31, v120, 7
    v_readlane_b32 s32, v120, 8
    v_readlane_b32 s33, v120, 9
    v_readlane_b32 s34, v120, 10
    v_readlane_b32 s35, v120, 11
    v_readlane_b32 s36, v120, 12
    v_readlane_b32 s37, v120, 13
    s_nop 3
    buffer_load_dwordx4 v125, s[52:55], s19 offen offset:1024 lds
    v_readlane_b32 s92, v123, 0
    v_readlane_b32 s93, v123, 4
    s_lshl_b32 s81, s78, 15
    s_waitcnt lgkmcnt(0)
    s_barrier
    ds_read_b128 v[24:27], v49
    ds_read_b128 v[28:31], v49 offset:1024
    s_add_u32 s88, s81, s79
    s_lshl_b32 s89, s3, 5
    s_add_u32 s88, s88, s89
    s_add_u32 s81, s81, 4194304
    s_lshl_b32 s92, s92, 12
    s_lshl_b32 s93, s93, 12
    s_add_u32 s94, s92, s81
    s_add_u32 s95, s93, s81
    s_xor_b32 s92, s94, 32768
    s_xor_b32 s93, s95, 32768
    s_lshl_b32 s76, s76, 11
    s_add_u32 s87, s80, s76
    s_xor_b32 s81, s78, 1
    s_mul_i32 s81, s81, 114688
    s_add_u32 s81, s81, s76
    s_waitcnt lgkmcnt(0)
    s_nop 0
    v_pk_add_f32 v[16:17], v[152:153], v[24:25]
    v_pk_add_f32 v[18:19], v[154:155], v[26:27]
    v_pk_add_f32 v[20:21], v[156:157], v[28:29]
    v_pk_add_f32 v[22:23], v[158:159], v[30:31]
    v_cvt_pk_bf16_f32 v24, v16, v17
    v_cvt_pk_bf16_f32 v25, v18, v19
    v_cndmask_b32 v16, v20, v21, s[70:71]
    buffer_load_dwordx4 v126, s[52:55], s19 offen offset:2048 lds
    v_cndmask_b32 v17, v22, v23, s[98:99]
    v_cvt_pk_bf16_f32 v26, v20, v20
    v_cvt_pk_bf16_f32 v27, v16, v21
    v_cvt_pk_bf16_f32 v28, v22, v22
    v_cvt_pk_bf16_f32 v29, v22, v22
    v_cvt_pk_bf16_f32 v30, v17, v23
    v_cvt_pk_bf16_f32 v31, v23, v23
    ds_write2st64_b64 v130, v[24:25], v[26:27] offset0:0 offset1:2
    ds_write_b128 v131, v[28:31] offset:2048
    s_add_u32 s86, s81, 6291456
    s_sub_u32 s81, s72, s75
    s_and_b32 s82, s81, 3
    s_lshl_b32 s82, s82, 14
    s_bfe_u32 s81, s81, 0x10002
    s_lshl_b32 s81, s81, 12
    s_add_u32 s82, s82, s81
    s_lshl_b32 s81, s3, 10
    s_add_u32 s82, s82, s81
    s_add_u32 s89, s82, 8192
    s_cmp_lt_u32 s72, 7
    s_cselect_b32 s66, 0x10000000, 0
    v_readlane_b32 s72, v122, 0
    v_readlane_b32 s73, v122, 1
    v_readlane_b32 s74, v122, 2
    v_readlane_b32 s75, v122, 3
    v_readlane_b32 s76, v122, 4
    v_readlane_b32 s77, v122, 5
    v_readlane_b32 s78, v122, 6
    v_readlane_b32 s79, v122, 7
    s_waitcnt lgkmcnt(0)
    s_barrier
    buffer_load_dwordx4 v127, s[52:55], s19 offen offset:3072 lds
    ds_read_b64 v[16:17], v132 offset:12480
    ds_read_b128 v[18:21], v132 offset:12488
    ds_read_b128 v[22:25], v132 offset:12504
    s_add_u32 s10, s49, 0
    s_nop 0
    buffer_load_dwordx4 v[72:75], v141, s[44:47], s10 offen sc1
    s_mov_b32 s10, 13631488
    buffer_load_dwordx4 v[76:79], v110, s[44:47], s10 offen sc1
    s_add_u32 s10, s49, 1048576
    buffer_load_dwordx4 v[80:83], v141, s[44:47], s10 offen sc1
    s_mov_b32 s10, 13635584
    buffer_load_dwordx4 v[84:87], v110, s[44:47], s10 offen sc1
    v_readlane_b32 s80, v122, 8
    v_readlane_b32 s81, v122, 9
    v_readlane_b32 s82, v122, 10
    v_readlane_b32 s83, v122, 11
    v_readlane_b32 s84, v122, 12
    v_readlane_b32 s85, v122, 13
    s_waitcnt vmcnt(12)
    s_nop 0
    ds_read_b64_tr_b16 v[160:161], v108 offset:0
    ds_read_b64_tr_b16 v[162:163], v108 offset:512
    ds_read_b64_tr_b16 v[164:165], v108 offset:1024
    ds_read_b64_tr_b16 v[166:167], v108 offset:1536
    s_waitcnt lgkmcnt(4)
    s_nop 0
    v_alignbit_b32 v28, v18, v17, 16
    ds_read_b64_tr_b16 v[168:169], v108 offset:2048
    v_alignbit_b32 v29, v19, v18, 16
    ds_read_b64_tr_b16 v[170:171], v108 offset:2560
    v_alignbit_b32 v30, v20, v19, 16
    ds_read_b64_tr_b16 v[172:173], v108 offset:3072
    v_alignbit_b32 v31, v21, v20, 16
    ds_read_b64_tr_b16 v[174:175], v108 offset:3584
    v_alignbit_b32 v32, v22, v21, 16
    ds_read_b64_tr_b16 v[176:177], v109 offset:0
    v_alignbit_b32 v33, v23, v22, 16
    ds_read_b64_tr_b16 v[178:179], v109 offset:512
    v_alignbit_b32 v34, v24, v23, 16
    ds_read_b64_tr_b16 v[180:181], v109 offset:1024
    v_alignbit_b32 v35, v25, v24, 16
    ds_read_b64_tr_b16 v[182:183], v109 offset:1536
    ds_write_b128 v132, v[28:31] offset:8328
    ds_read_b64_tr_b16 v[184:185], v109 offset:2048
    ds_write_b128 v132, v[32:35] offset:8344
    ds_read_b64_tr_b16 v[186:187], v109 offset:2560
    v_alignbit_b32 v36, v17, v16, 16
    ds_read_b64_tr_b16 v[188:189], v109 offset:3072
    v_alignbit_b32 v37, v18, v17, 16
    ds_read_b64_tr_b16 v[190:191], v109 offset:3584
    v_alignbit_b32 v38, v19, v18, 16
    v_alignbit_b32 v39, v20, v19, 16
    v_alignbit_b32 v40, v21, v20, 16
    v_alignbit_b32 v41, v22, v21, 16
    v_alignbit_b32 v42, v23, v22, 16
    v_alignbit_b32 v43, v24, v23, 16
    ds_write_b128 v132, v[36:39] offset:8
    ds_write_b128 v132, v[40:43] offset:24
    v_pk_mov_b32 v[56:57], v[16:17], v[18:19] op_sel:[1,0]
    v_pk_mov_b32 v[58:59], v[18:19], v[20:21] op_sel:[1,0]
    v_pk_mov_b32 v[60:61], v[20:21], v[22:23] op_sel:[1,0]
    v_pk_mov_b32 v[62:63], v[22:23], v[24:25] op_sel:[1,0]
    ds_write_b128 v132, v[56:59] offset:4168
    ds_write_b128 v132, v[60:63] offset:4184
    s_waitcnt lgkmcnt(4)
    s_mov_b32 m0, s38
    s_nop 0
    buffer_load_dwordx4 v124, s[52:55], s20 offen offset:0 lds
    v_mfma_f32_16x16x32_bf16 v[148:151], v[144:147], v[160:163], 0
    v_mfma_f32_16x16x32_bf16 v[148:151], v[144:147], v[164:167], v[148:151]
    v_mfma_f32_16x16x32_bf16 v[148:151], v[144:147], v[168:171], v[148:151]
    buffer_load_dwordx4 v125, s[52:55], s20 offen offset:1024 lds
    v_mfma_f32_16x16x32_bf16 v[148:151], v[144:147], v[172:175], v[148:151]
    v_mfma_f32_16x16x32_bf16 v[148:151], v[144:147], v[176:179], v[148:151]
    v_mfma_f32_16x16x32_bf16 v[148:151], v[144:147], v[180:183], v[148:151]
    buffer_load_dwordx4 v126, s[52:55], s20 offen offset:2048 lds
    v_mfma_f32_16x16x32_bf16 v[148:151], v[144:147], v[184:187], v[148:151]
    v_mfma_f32_16x16x32_bf16 v[148:151], v[144:147], v[188:191], v[148:151]
    buffer_load_dwordx4 v127, s[52:55], s20 offen offset:3072 lds
    s_mov_b32 m0, s39
    s_nop 0
    buffer_load_dwordx4 v124, s[52:55], s21 offen offset:0 lds
    s_waitcnt vmcnt(9)
    ds_read_b64_tr_b16 v[192:193], v108 offset:8192
    ds_read_b64_tr_b16 v[194:195], v108 offset:8704
    ds_read_b64_tr_b16 v[196:197], v108 offset:9216
    ds_read_b64_tr_b16 v[198:199], v108 offset:9728
    ds_read_b64_tr_b16 v[200:201], v108 offset:10240
    ds_read_b64_tr_b16 v[202:203], v108 offset:10752
    ds_read_b64_tr_b16 v[204:205], v108 offset:11264
    ds_read_b64_tr_b16 v[206:207], v108 offset:11776
    ds_read_b64_tr_b16 v[208:209], v109 offset:8192
    ds_read_b64_tr_b16 v[210:211], v109 offset:8704
    ds_read_b64_tr_b16 v[212:213], v109 offset:9216
    ds_read_b64_tr_b16 v[214:215], v109 offset:9728
    ds_read_b64_tr_b16 v[216:217], v109 offset:10240
    ds_read_b64_tr_b16 v[218:219], v109 offset:10752
    ds_read_b64_tr_b16 v[220:221], v109 offset:11264
    ds_read_b64_tr_b16 v[222:223], v109 offset:11776
    s_waitcnt lgkmcnt(8)
    v_mfma_f32_16x16x32_bf16 v[148:151], v[144:147], v[192:195], v[148:151]
    v_mfma_f32_16x16x32_bf16 v[148:151], v[144:147], v[196:199], v[148:151]
    v_mfma_f32_16x16x32_bf16 v[148:151], v[144:147], v[200:203], v[148:151]
    v_mfma_f32_16x16x32_bf16 v[148:151], v[144:147], v[204:207], v[148:151]
    s_waitcnt lgkmcnt(0)
    v_mfma_f32_16x16x32_bf16 v[148:151], v[144:147], v[208:211], v[148:151]
    v_mfma_f32_16x16x32_bf16 v[148:151], v[144:147], v[212:215], v[148:151]
    v_mfma_f32_16x16x32_bf16 v[148:151], v[144:147], v[216:219], v[148:151]
    v_mfma_f32_16x16x32_bf16 v[148:151], v[144:147], v[220:223], v[148:151]
    buffer_load_dwordx4 v125, s[52:55], s21 offen offset:1024 lds
    buffer_load_dwordx4 v126, s[52:55], s21 offen offset:2048 lds
    buffer_load_dwordx4 v127, s[52:55], s21 offen offset:3072 lds
    s_waitcnt vmcnt(8)
    v_xor_b32 v88, s68, v74
    s_mov_b32 m0, s40
    s_nop 0
    buffer_load_dwordx4 v124, s[52:55], s22 offen offset:0 lds
    v_bitop3_b32 v88, v88, v79, s68 bitop3:0xf6
    v_bitop3_b32 v88, v88, v82, s68 bitop3:0xf6
    v_bitop3_b32 v88, v88, v87, s68 bitop3:0xf6
    v_bitop3_b32 v88, v88, v75, s69 bitop3:0xf6
    v_bitop3_b32 v88, v88, v83, s69 bitop3:0xf6
    v_cmp_ne_u32 vcc, 0, v88
    s_cbranch_vccnz LpA
LpA_ret:
    s_add_u32 s10, s49, 2097152
    buffer_load_dwordx4 v[92:95], v141, s[44:47], s10 offen sc1
    s_mov_b32 s10, 13639680
    buffer_load_dwordx4 v[96:99], v110, s[44:47], s10 offen sc1
    s_add_u32 s10, s49, 3145728
    buffer_load_dwordx4 v[100:103], v141, s[44:47], s10 offen sc1
    s_mov_b32 s10, 13643776
    buffer_load_dwordx4 v[104:107], v110, s[44:47], s10 offen sc1
    v_and_b32 v17, s70, v72
    v_lshlrev_b32 v16, 16, v72
    v_and_b32 v19, s70, v73
    v_lshlrev_b32 v18, 16, v73
    v_and_b32 v21, s70, v78
    v_lshlrev_b32 v20, 16, v78
    v_pk_add_f32 v[16:17], v[16:17], v[20:21] op_sel:[0,0] op_sel_hi:[1,0] neg_lo:[0,1] neg_hi:[0,1]
    v_pk_add_f32 v[18:19], v[18:19], v[20:21] op_sel:[0,1] op_sel_hi:[1,1] neg_lo:[0,1] neg_hi:[0,1]
    v_cvt_pk_bf16_f32 v20, v16, v17
    v_cvt_pk_bf16_f32 v21, v18, v19
    v_and_b32 v17, s70, v20
    v_lshlrev_b32 v16, 16, v20
    v_and_b32 v19, s70, v21
    v_lshlrev_b32 v18, 16, v21
    v_pk_mul_f32 v[16:17], v[16:17], v[76:77] op_sel:[0,0] op_sel_hi:[1,0]
    v_pk_mul_f32 v[18:19], v[18:19], v[76:77] op_sel:[0,1] op_sel_hi:[1,1]
    v_cvt_pk_bf16_f32 v24, v18, v16
    v_cvt_pk_bf16_f32 v25, v19, v17
    ds_write2st64_b32 v111, v24, v25 offset0:12 offset1:49
    ds_write2st64_b32 v112, v24, v25 offset0:12 offset1:49
    v_perm_b32 v22, v73, v72, s96
    v_perm_b32 v23, v73, v72, s101
    ds_write2st64_b32 v113, v22, v23 offset0:0 offset1:16
    v_and_b32 v17, s70, v80
    v_lshlrev_b32 v16, 16, v80
    v_and_b32 v19, s70, v81
    v_lshlrev_b32 v18, 16, v81
    v_and_b32 v21, s70, v86
    v_lshlrev_b32 v20, 16, v86
    v_pk_add_f32 v[16:17], v[16:17], v[20:21] op_sel:[0,0] op_sel_hi:[1,0] neg_lo:[0,1] neg_hi:[0,1]
    v_pk_add_f32 v[18:19], v[18:19], v[20:21] op_sel:[0,1] op_sel_hi:[1,1] neg_lo:[0,1] neg_hi:[0,1]
    v_cvt_pk_bf16_f32 v20, v16, v17
    v_cvt_pk_bf16_f32 v21, v18, v19
    v_and_b32 v17, s70, v20
    v_lshlrev_b32 v16, 16, v20
    v_and_b32 v19, s70, v21
    v_lshlrev_b32 v18, 16, v21
    v_pk_mul_f32 v[16:17], v[16:17], v[84:85] op_sel:[0,0] op_sel_hi:[1,0]
    v_pk_mul_f32 v[18:19], v[18:19], v[84:85] op_sel:[0,1] op_sel_hi:[1,1]
    v_cvt_pk_bf16_f32 v28, v18, v16
    v_cvt_pk_bf16_f32 v29, v19, v17
    ds_write2st64_b32 v111, v28, v29 offset0:8 offset1:45
    buffer_load_dwordx4 v125, s[52:55], s22 offen offset:1024 lds
    ds_write2st64_b32 v112, v28, v29 offset0:8 offset1:45
    v_perm_b32 v26, v81, v80, s96
    v_perm_b32 v27, v81, v80, s101
    ds_write2st64_b32 v113, v26, v27 offset0:4 offset1:20
    s_waitcnt lgkmcnt(0)
    s_barrier
    ds_read_b128 v[16:19], v14 offset:0
    ds_read_b128 v[20:23], v15 offset:3584
    ds_read_b128 v[24:27], v14 offset:512
    ds_read_b128 v[28:31], v15 offset:3072
    ds_read_b128 v[32:35], v14 offset:1024
    ds_read_b128 v[36:39], v15 offset:2560
    ds_read_b128 v[40:43], v14 offset:1536
    ds_read_b128 v[44:47], v15 offset:2048
    buffer_load_dwordx4 v126, s[52:55], s22 offen offset:2048 lds
    buffer_load_dwordx4 v127, s[52:55], s22 offen offset:3072 lds
    s_waitcnt lgkmcnt(6)
    v_mfma_f32_16x16x32_bf16 v[60:63], v[16:19], v[20:23], 0
    ds_read_b128 a[160:163], v14 offset:64
    ds_read_b128 a[164:167], v15 offset:3648
    ds_read_b128 v[76:79], v117 offset:2048
    s_waitcnt lgkmcnt(8)
    v_mfma_f32_16x16x32_bf16 v[64:67], v[24:27], v[20:23], 0
    ds_read_b128 a[168:171], v14 offset:576
    ds_read_b128 v[80:83], v116 offset:0
    s_waitcnt lgkmcnt(9)
    v_mfma_f32_16x16x32_bf16 v[64:67], v[16:19], v[28:31], v[64:67]
    ds_read_b128 a[172:175], v15 offset:3136
    s_mov_b32 m0, s41
    s_nop 0
    buffer_load_dwordx4 v124, s[52:55], s23 offen offset:0 lds
    s_waitcnt vmcnt(9)
    ds_read_b64_tr_b16 v[224:225], v108 offset:0
    v_mfma_f32_16x16x32_bf16 v[68:71], v[24:27], v[28:31], 0
    ds_read_b128 a[176:179], v14 offset:1088
    ds_read_b64_tr_b16 v[226:227], v108 offset:512
    s_waitcnt lgkmcnt(12)
    v_mfma_f32_16x16x32_bf16 v[68:71], v[32:35], v[20:23], v[68:71]
    ds_read_b128 a[180:183], v15 offset:2624
    ds_read_b64_tr_b16 v[228:229], v108 offset:1024
    v_mfma_f32_16x16x32_bf16 v[72:75], v[32:35], v[28:31], 0
    ds_read_b128 a[184:187], v14 offset:1600
    ds_read_b64_tr_b16 v[230:231], v108 offset:1536
    s_waitcnt lgkmcnt(15)
    v_mfma_f32_16x16x32_bf16 v[68:71], v[16:19], v[36:39], v[68:71]
    ds_read_b128 a[188:191], v15 offset:2112
    buffer_load_dwordx4 v125, s[52:55], s23 offen offset:1024 lds
    ds_read_b64_tr_b16 v[232:233], v108 offset:2048
    v_mfma_f32_16x16x32_bf16 v[72:75], v[24:27], v[36:39], v[72:75]
    ds_read_b64_tr_b16 v[234:235], v108 offset:2560
    ds_read_b64_tr_b16 v[236:237], v108 offset:3072
    s_waitcnt lgkmcnt(15)
    v_mfma_f32_16x16x32_bf16 v[72:75], v[40:43], v[20:23], v[72:75]
    s_waitcnt lgkmcnt(12)
    ds_read_b64_tr_b16 v[238:239], v108 offset:3584
    v_mfma_f32_16x16x32_bf16 v[72:75], v[16:19], v[44:47], v[72:75]
    v_and_b32_e64 v85, s70, v79
    ds_read_b64_tr_b16 v[240:241], v109 offset:0
    s_waitcnt lgkmcnt(11)
    v_mfma_f32_16x16x32_bf16 v[60:63], a[160:163], a[164:167], v[60:63]
    ds_read_b128 v[16:19], v14 offset:128
    ds_read_b128 v[20:23], v15 offset:3712
    v_lshlrev_b32 v84, 16, v79
    ds_read_b64_tr_b16 v[242:243], v109 offset:512
    v_mfma_f32_16x16x32_bf16 v[64:67], a[168:171], a[164:167], v[64:67]
    ds_read_b128 v[24:27], v14 offset:640
    v_mul_f32_e64 v84, v84, v118
    ds_read_b64_tr_b16 v[244:245], v109 offset:1024
    v_mfma_f32_16x16x32_bf16 v[64:67], a[160:163], a[172:175], v[64:67]
    ds_read_b128 v[28:31], v15 offset:3200
    v_mul_f32_e64 v85, v85, v118
    ds_read_b64_tr_b16 v[246:247], v109 offset:1536
    v_mfma_f32_16x16x32_bf16 v[68:71], a[168:171], a[172:175], v[68:71]
    ds_read_b128 v[32:35], v14 offset:1152
    v_cvt_pk_bf16_f32 v86, v85, v84
    ds_read_b64_tr_b16 v[248:249], v109 offset:2048
    v_mfma_f32_16x16x32_bf16 v[68:71], a[176:179], a[164:167], v[68:71]
    ds_read_b128 v[36:39], v15 offset:2688
    v_and_b32_e64 v153, s70, v86
    ds_read_b64_tr_b16 v[250:251], v109 offset:2560
    v_mfma_f32_16x16x32_bf16 v[72:75], a[176:179], a[172:175], v[72:75]
    ds_read_b128 v[40:43], v14 offset:1664
    v_lshlrev_b32_e64 v152, 16, v86
    ds_read_b64_tr_b16 v[252:253], v109 offset:3072
    s_waitcnt lgkmcnt(15)
    v_mfma_f32_16x16x32_bf16 v[68:71], a[160:163], a[180:183], v[68:71]
    ds_read_b128 v[44:47], v15 offset:2176
    v_and_b32 v131, s70, v80
    ds_read_b64_tr_b16 v[254:255], v109 offset:3584
    v_mfma_f32_16x16x32_bf16 v[72:75], a[168:171], a[180:183], v[72:75]
    v_lshlrev_b32 v130, 16, v80
    v_and_b32 v85, s70, v78
    v_mfma_f32_16x16x32_bf16 v[72:75], a[184:187], a[164:167], v[72:75]
    v_lshlrev_b32 v84, 16, v78
    v_mul_f32 v84, v84, v118
    v_mfma_f32_16x16x32_bf16 v[72:75], a[160:163], a[188:191], v[72:75]
    v_mul_f32_e64 v85, v85, v118
    v_cvt_pk_bf16_f32 v86, v85, v84
    s_waitcnt lgkmcnt(7)
    v_mfma_f32_16x16x32_bf16 v[60:63], v[16:19], v[20:23], v[60:63]
    ds_read_b128 a[160:163], v14 offset:192
    ds_read_b128 a[164:167], v15 offset:3776
    v_and_b32 v155, s70, v86
    v_mfma_f32_16x16x32_bf16 v[64:67], v[24:27], v[20:23], v[64:67]
    ds_read_b128 a[168:171], v14 offset:704
    v_lshlrev_b32_e64 v154, 16, v86
    v_mfma_f32_16x16x32_bf16 v[64:67], v[16:19], v[28:31], v[64:67]
    ds_read_b128 a[172:175], v15 offset:3264
    v_and_b32_e64 v133, s70, v81
    v_mfma_f32_16x16x32_bf16 v[68:71], v[24:27], v[28:31], v[68:71]
    ds_read_b128 a[176:179], v14 offset:1216
    v_lshlrev_b32_e64 v132, 16, v81
    v_mfma_f32_16x16x32_bf16 v[68:71], v[32:35], v[20:23], v[68:71]
    ds_read_b128 a[180:183], v15 offset:2752
    v_and_b32_e64 v85, s70, v77
    v_mfma_f32_16x16x32_bf16 v[72:75], v[32:35], v[28:31], v[72:75]
    ds_read_b128 a[184:187], v14 offset:1728
    v_lshlrev_b32 v84, 16, v77
    s_waitcnt lgkmcnt(8)
    v_mfma_f32_16x16x32_bf16 v[68:71], v[16:19], v[36:39], v[68:71]
    ds_read_b128 a[188:191], v15 offset:2240
    v_mul_f32_e64 v84, v84, v118
    v_mfma_f32_16x16x32_bf16 v[72:75], v[24:27], v[36:39], v[72:75]
    v_mul_f32_e64 v85, v85, v118
    v_cvt_pk_bf16_f32 v86, v85, v84
    v_mfma_f32_16x16x32_bf16 v[72:75], v[40:43], v[20:23], v[72:75]
    v_and_b32 v157, s70, v86
    v_lshlrev_b32 v156, 16, v86
    v_mfma_f32_16x16x32_bf16 v[72:75], v[16:19], v[44:47], v[72:75]
    v_and_b32_e64 v135, s70, v82
    buffer_load_dwordx4 v126, s[52:55], s23 offen offset:2048 lds
    s_waitcnt lgkmcnt(3)
    v_mfma_f32_16x16x32_bf16 v[60:63], a[160:163], a[164:167], v[60:63]
    ds_read_b128 v[16:19], v14 offset:2048
    ds_read_b128 v[20:23], v15 offset:3584
    v_lshlrev_b32 v134, 16, v82
    v_mfma_f32_16x16x32_bf16 v[64:67], a[168:171], a[164:167], v[64:67]
    ds_read_b128 v[24:27], v14 offset:1536
    ds_read_b128 v[28:31], v15 offset:3072
    v_and_b32_e64 v85, s70, v76
    v_mfma_f32_16x16x32_bf16 v[64:67], a[160:163], a[172:175], v[64:67]
    ds_read_b128 v[32:35], v14 offset:2560
    ds_read_b128 v[36:39], v15 offset:2560
    v_lshlrev_b32_e64 v84, 16, v76
    v_mfma_f32_16x16x32_bf16 v[68:71], a[168:171], a[172:175], v[68:71]
    ds_read_b128 v[40:43], v14 offset:1024
    ds_read_b128 v[44:47], v15 offset:2048
    v_mul_f32_e64 v84, v84, v118
    buffer_load_dwordx4 v127, s[52:55], s23 offen offset:3072 lds
    v_mfma_f32_16x16x32_bf16 v[68:71], a[176:179], a[164:167], v[68:71]
    ds_read_b128 v[48:51], v14 offset:3072
    v_mul_f32_e64 v85, v85, v118
    v_mfma_f32_16x16x32_bf16 v[72:75], a[176:179], a[172:175], v[72:75]
    ds_read_b128 v[52:55], v14 offset:512
    v_cvt_pk_bf16_f32 v86, v85, v84
    s_waitcnt lgkmcnt(10)
    v_mfma_f32_16x16x32_bf16 v[68:71], a[160:163], a[180:183], v[68:71]
    ds_read_b128 v[56:59], v14 offset:3584
    v_and_b32 v159, s70, v86
    v_mfma_f32_16x16x32_bf16 v[72:75], a[168:171], a[180:183], v[72:75]
    v_lshlrev_b32_e64 v158, 16, v86
    s_mov_b32 m0, s38
    s_nop 0
    buffer_load_dwordx4 v8, s[56:59], s24 offen offset:0 lds
    v_mfma_f32_16x16x32_bf16 v[72:75], a[184:187], a[164:167], v[72:75]
    v_and_b32 v137, s70, v83
    v_lshlrev_b32 v136, 16, v83
    v_mfma_f32_16x16x32_bf16 v[72:75], a[160:163], a[188:191], v[72:75]
    s_nop 3
    s_waitcnt lgkmcnt(5)
    v_mfma_f32_16x16x32_bf16 v[76:79], v[16:19], v[20:23], 0
    ds_read_b128 a[160:163], v14 offset:2112
    ds_write_b128 v114, v[60:63] offset:0
    ds_write_b128 v114, v[64:67] offset:1024
    ds_write_b128 v114, v[68:71] offset:2048
    buffer_load_dwordx4 v9, s[56:59], s24 offen offset:1024 lds
    v_mfma_f32_16x16x32_bf16 v[76:79], v[24:27], v[28:31], v[76:79]
    ds_read_b128 a[164:167], v15 offset:3648
    ds_write_b128 v114, v[72:75] offset:3072
    v_mfma_f32_16x16x32_bf16 v[80:83], v[16:19], v[28:31], 0
    ds_read_b128 a[168:171], v14 offset:1600
    buffer_load_dwordx4 v10, s[56:59], s24 offen offset:2048 lds
    v_mfma_f32_16x16x32_bf16 v[80:83], v[32:35], v[20:23], v[80:83]
    ds_read_b128 a[172:175], v15 offset:3136
    v_mfma_f32_16x16x32_bf16 v[84:87], v[32:35], v[28:31], 0
    ds_read_b128 a[176:179], v14 offset:2624
    v_mfma_f32_16x16x32_bf16 v[80:83], v[24:27], v[36:39], v[80:83]
    ds_read_b128 a[180:183], v15 offset:2624
    v_mfma_f32_16x16x32_bf16 v[84:87], v[16:19], v[36:39], v[84:87]
    ds_read_b128 a[184:187], v14 offset:1088
    s_waitcnt lgkmcnt(5)
    s_barrier
    ds_read_b128 v[60:63], v115 offset:0
    ds_read_b128 v[64:67], v119 offset:0
    ds_read_b128 v[68:71], v115 offset:4096
    buffer_load_dwordx4 v11, s[56:59], s24 offen offset:3072 lds
    v_mfma_f32_16x16x32_bf16 v[88:91], v[32:35], v[36:39], 0
    ds_read_b128 a[188:191], v15 offset:2112
    ds_read_b128 v[72:75], v119 offset:4096
    v_mfma_f32_16x16x32_bf16 v[76:79], v[40:43], v[36:39], v[76:79]
    ds_read_b128 a[192:195], v14 offset:3136
    v_mfma_f32_16x16x32_bf16 v[80:83], v[40:43], v[44:47], v[80:83]
    ds_read_b128 a[196:199], v14 offset:576
    v_mfma_f32_16x16x32_bf16 v[84:87], v[24:27], v[44:47], v[84:87]
    ds_read_b128 a[200:203], v14 offset:3648
    s_mov_b32 m0, s39
    s_nop 0
    buffer_load_dwordx4 v8, s[56:59], s25 offen offset:0 lds
    v_mfma_f32_16x16x32_bf16 v[88:91], v[16:19], v[44:47], v[88:91]
    v_mfma_f32_16x16x32_bf16 v[84:87], v[48:51], v[20:23], v[84:87]
    v_mfma_f32_16x16x32_bf16 v[88:91], v[48:51], v[28:31], v[88:91]
    v_mfma_f32_16x16x32_bf16 v[76:79], v[52:55], v[44:47], v[76:79]
    s_waitcnt lgkmcnt(3)
    v_add_f32 v60, v60, v68
    v_add_f32 v61, v61, v69
    v_add_f32 v60, v60, v152
    v_add_f32_e64 v61, v61, v153
    v_cvt_pk_bf16_f32 v60, v60, v61
    v_and_b32 v61, s70, v60
    v_lshlrev_b32 v60, 16, v60
    buffer_load_dwordx4 v9, s[56:59], s25 offen offset:1024 lds
    v_mfma_f32_16x16x32_bf16 v[88:91], v[56:59], v[20:23], v[88:91]
    v_add_f32 v60, v60, v130
    v_add_f32 v61, v61, v131
    v_cvt_pk_bf16_f32 v152, v60, v61
    v_add_f32 v62, v62, v70
    v_add_f32 v63, v63, v71
    v_add_f32 v62, v62, v154
    v_add_f32 v63, v63, v155
    v_cvt_pk_bf16_f32 v62, v62, v63
    v_mfma_f32_16x16x32_bf16 v[76:79], a[160:163], a[164:167], v[76:79]
    ds_read_b128 v[16:19], v14 offset:2176
    v_and_b32 v63, s70, v62
    v_lshlrev_b32 v62, 16, v62
    v_add_f32 v62, v62, v132
    v_add_f32 v63, v63, v133
    v_cvt_pk_bf16_f32 v153, v62, v63
    v_add_f32 v64, v64, v72
    v_add_f32 v65, v65, v73
    v_add_f32_e64 v64, v64, v156
    buffer_load_dwordx4 v10, s[56:59], s25 offen offset:2048 lds
    v_mfma_f32_16x16x32_bf16 v[76:79], a[168:171], a[172:175], v[76:79]
    ds_read_b128 v[20:23], v15 offset:3712
    v_add_f32_e64 v65, v65, v157
    v_cvt_pk_bf16_f32 v64, v64, v65
    v_and_b32 v65, s70, v64
    v_lshlrev_b32 v64, 16, v64
    v_add_f32 v64, v64, v134
    v_add_f32 v65, v65, v135
    v_cvt_pk_bf16_f32 v154, v64, v65
    v_add_f32_e64 v66, v66, v74
    v_mfma_f32_16x16x32_bf16 v[80:83], a[160:163], a[172:175], v[80:83]
    ds_read_b128 v[24:27], v14 offset:1664
    v_add_f32 v67, v67, v75
    v_add_f32 v66, v66, v158
    v_add_f32_e64 v67, v67, v159
    v_cvt_pk_bf16_f32 v66, v66, v67
    v_and_b32 v67, s70, v66
    v_lshlrev_b32 v66, 16, v66
    v_add_f32 v66, v66, v136
    v_add_f32 v67, v67, v137
    buffer_load_dwordx4 v11, s[56:59], s25 offen offset:3072 lds
    s_waitcnt vmcnt(8)
    ds_read_b64_tr_b16 a[224:225], v108 offset:8192
    v_mfma_f32_16x16x32_bf16 v[80:83], a[176:179], a[164:167], v[80:83]
    ds_read_b128 v[28:31], v15 offset:3200
    v_cvt_pk_bf16_f32 v155, v66, v67
    buffer_store_dwordx4 v[152:155], v2, s[44:47], s42 offen sc1
    v_xor_b32 v60, s68, v94
    v_bitop3_b32 v60, v60, v99, s68 bitop3:0xf6
    v_bitop3_b32 v60, v60, v102, s68 bitop3:0xf6
    v_bitop3_b32 v60, v60, v107, s68 bitop3:0xf6
    ds_read_b64_tr_b16 a[226:227], v108 offset:8704
    v_mfma_f32_16x16x32_bf16 v[84:87], a[176:179], a[172:175], v[84:87]
    ds_read_b128 v[32:35], v14 offset:2688
    v_bitop3_b32 v60, v60, v95, s69 bitop3:0xf6
    ds_read_b64_tr_b16 a[228:229], v108 offset:9216
    v_mfma_f32_16x16x32_bf16 v[80:83], a[168:171], a[180:183], v[80:83]
    ds_read_b128 v[36:39], v15 offset:2688
    v_bitop3_b32 v60, v60, v103, s69 bitop3:0xf6
    ds_read_b64_tr_b16 a[230:231], v108 offset:9728
    v_mfma_f32_16x16x32_bf16 v[84:87], a[160:163], a[180:183], v[84:87]
    ds_read_b128 v[40:43], v14 offset:1152
    v_cmp_ne_u32 vcc, 0, v60
    s_cbranch_vccnz LpB
LpB_ret:
    ds_read_b64_tr_b16 a[232:233], v108 offset:10240
    v_mfma_f32_16x16x32_bf16 v[88:91], a[176:179], a[180:183], v[88:91]
    ds_read_b128 v[44:47], v15 offset:2176
    v_and_b32_e64 v61, s70, v92
    ds_read_b64_tr_b16 a[234:235], v108 offset:10752
    s_waitcnt lgkmcnt(14)
    v_mfma_f32_16x16x32_bf16 v[76:79], a[184:187], a[180:183], v[76:79]
    ds_read_b128 v[48:51], v14 offset:3200
    v_lshlrev_b32 v60, 16, v92
    ds_read_b64_tr_b16 a[236:237], v108 offset:11264
    v_mfma_f32_16x16x32_bf16 v[80:83], a[184:187], a[188:191], v[80:83]
    ds_read_b128 v[52:55], v14 offset:640
    v_and_b32_e64 v63, s70, v93
    ds_read_b64_tr_b16 a[238:239], v108 offset:11776
    v_mfma_f32_16x16x32_bf16 v[84:87], a[168:171], a[188:191], v[84:87]
    ds_read_b128 v[56:59], v14 offset:3712
    v_lshlrev_b32_e64 v62, 16, v93
    ds_read_b64_tr_b16 a[240:241], v109 offset:8192
    v_mfma_f32_16x16x32_bf16 v[88:91], a[160:163], a[188:191], v[88:91]
    v_and_b32_e64 v65, s70, v98
    ds_read_b64_tr_b16 a[242:243], v109 offset:8704
    v_mfma_f32_16x16x32_bf16 v[84:87], a[192:195], a[164:167], v[84:87]
    v_lshlrev_b32_e64 v64, 16, v98
    ds_read_b64_tr_b16 a[244:245], v109 offset:9216
    v_mfma_f32_16x16x32_bf16 v[88:91], a[192:195], a[172:175], v[88:91]
    v_sub_f32_e64 v60, v60, v64
    ds_read_b64_tr_b16 a[246:247], v109 offset:9728
    v_mfma_f32_16x16x32_bf16 v[76:79], a[196:199], a[188:191], v[76:79]
    v_sub_f32_e64 v61, v61, v64
    ds_read_b64_tr_b16 a[248:249], v109 offset:10240
    v_mfma_f32_16x16x32_bf16 v[88:91], a[200:203], a[164:167], v[88:91]
    v_sub_f32_e64 v62, v62, v65
    ds_read_b64_tr_b16 a[250:251], v109 offset:10752
    s_waitcnt lgkmcnt(15)
    v_mfma_f32_16x16x32_bf16 v[76:79], v[16:19], v[20:23], v[76:79]
    ds_read_b128 a[160:163], v14 offset:2240
    v_sub_f32 v63, v63, v65
    ds_read_b64_tr_b16 a[252:253], v109 offset:11264
    v_mfma_f32_16x16x32_bf16 v[76:79], v[24:27], v[28:31], v[76:79]
    ds_read_b128 a[164:167], v15 offset:3776
    v_cvt_pk_bf16_f32 v64, v60, v61
    ds_read_b64_tr_b16 a[254:255], v109 offset:11776
    v_mfma_f32_16x16x32_bf16 v[80:83], v[16:19], v[28:31], v[80:83]
    ds_read_b128 a[168:171], v14 offset:1728
    v_cvt_pk_bf16_f32 v65, v62, v63
    v_mfma_f32_16x16x32_bf16 v[80:83], v[32:35], v[20:23], v[80:83]
    ds_read_b128 a[172:175], v15 offset:3264
    v_and_b32_e64 v61, s70, v64
    v_mfma_f32_16x16x32_bf16 v[84:87], v[32:35], v[28:31], v[84:87]
    ds_read_b128 a[176:179], v14 offset:2752
    v_lshlrev_b32_e64 v60, 16, v64
    v_mfma_f32_16x16x32_bf16 v[80:83], v[24:27], v[36:39], v[80:83]
    ds_read_b128 a[180:183], v15 offset:2752
    v_and_b32_e64 v63, s70, v65
    v_mfma_f32_16x16x32_bf16 v[84:87], v[16:19], v[36:39], v[84:87]
    ds_read_b128 a[184:187], v14 offset:1216
    v_lshlrev_b32_e64 v62, 16, v65
    v_mfma_f32_16x16x32_bf16 v[88:91], v[32:35], v[36:39], v[88:91]
    ds_read_b128 a[188:191], v15 offset:2240
    v_mul_f32 v60, v60, v96
    s_waitcnt lgkmcnt(15)
    v_mfma_f32_16x16x32_bf16 v[76:79], v[40:43], v[36:39], v[76:79]
    ds_read_b128 a[192:195], v14 offset:3264
    v_mul_f32_e64 v61, v61, v96
    v_mfma_f32_16x16x32_bf16 v[80:83], v[40:43], v[44:47], v[80:83]
    ds_read_b128 a[196:199], v14 offset:704
    v_mul_f32_e64 v62, v62, v97
    v_mfma_f32_16x16x32_bf16 v[84:87], v[24:27], v[44:47], v[84:87]
    ds_read_b128 a[200:203], v14 offset:3776
    v_mul_f32_e64 v63, v63, v97
    v_mfma_f32_16x16x32_bf16 v[88:91], v[16:19], v[44:47], v[88:91]
    v_cvt_pk_bf16_f32 v68, v62, v60
    s_waitcnt lgkmcnt(9)
    s_mov_b32 m0, s40
    s_nop 0
    buffer_load_dwordx4 v8, s[56:59], s26 offen offset:0 lds
    v_mfma_f32_16x16x32_bf16 v[84:87], v[48:51], v[20:23], v[84:87]
    v_cvt_pk_bf16_f32 v69, v63, v61
    ds_write2st64_b32 v111, v68, v69 offset0:4 offset1:41
    v_mfma_f32_16x16x32_bf16 v[88:91], v[48:51], v[28:31], v[88:91]
    ds_write2st64_b32 v112, v68, v69 offset0:4 offset1:41
    buffer_load_dwordx4 v9, s[56:59], s26 offen offset:1024 lds
    v_mfma_f32_16x16x32_bf16 v[76:79], v[52:55], v[44:47], v[76:79]
    v_perm_b32 v66, v93, v92, s96
    v_perm_b32 v67, v93, v92, s101
    v_mfma_f32_16x16x32_bf16 v[88:91], v[56:59], v[20:23], v[88:91]
    ds_write2st64_b32 v113, v66, v67 offset0:8 offset1:24
    s_waitcnt lgkmcnt(8)
    v_mfma_f32_16x16x32_bf16 v[76:79], a[160:163], a[164:167], v[76:79]
    v_and_b32 v61, s70, v100
    v_lshlrev_b32 v60, 16, v100
    v_mfma_f32_16x16x32_bf16 v[76:79], a[168:171], a[172:175], v[76:79]
    v_and_b32 v63, s70, v101
    v_lshlrev_b32 v62, 16, v101
    v_mfma_f32_16x16x32_bf16 v[80:83], a[160:163], a[172:175], v[80:83]
    v_and_b32 v65, s70, v106
    v_lshlrev_b32 v64, 16, v106
    v_mfma_f32_16x16x32_bf16 v[80:83], a[176:179], a[164:167], v[80:83]
    v_sub_f32 v60, v60, v64
    v_sub_f32 v61, v61, v64
    v_mfma_f32_16x16x32_bf16 v[84:87], a[176:179], a[172:175], v[84:87]
    v_sub_f32 v62, v62, v65
    v_sub_f32 v63, v63, v65
    v_mfma_f32_16x16x32_bf16 v[80:83], a[168:171], a[180:183], v[80:83]
    v_cvt_pk_bf16_f32 v64, v60, v61
    v_cvt_pk_bf16_f32 v65, v62, v63
    v_mfma_f32_16x16x32_bf16 v[84:87], a[160:163], a[180:183], v[84:87]
    v_and_b32_e64 v61, s70, v64
    buffer_load_dwordx4 v10, s[56:59], s26 offen offset:2048 lds
    v_mfma_f32_16x16x32_bf16 v[88:91], a[176:179], a[180:183], v[88:91]
    v_lshlrev_b32 v60, 16, v64
    v_and_b32_e64 v63, s70, v65
    s_waitcnt lgkmcnt(3)
    v_mfma_f32_16x16x32_bf16 v[76:79], a[184:187], a[180:183], v[76:79]
    v_lshlrev_b32 v62, 16, v65
    v_mul_f32 v60, v60, v104
    v_mfma_f32_16x16x32_bf16 v[80:83], a[184:187], a[188:191], v[80:83]
    v_mul_f32 v61, v61, v104
    v_mul_f32 v62, v62, v105
    v_mfma_f32_16x16x32_bf16 v[84:87], a[168:171], a[188:191], v[84:87]
    v_mul_f32_e64 v63, v63, v105
    v_cvt_pk_bf16_f32 v72, v62, v60
    v_mfma_f32_16x16x32_bf16 v[88:91], a[160:163], a[188:191], v[88:91]
    v_cvt_pk_bf16_f32 v73, v63, v61
    ds_write2st64_b32 v111, v72, v73 offset0:0 offset1:37
    v_mfma_f32_16x16x32_bf16 v[84:87], a[192:195], a[164:167], v[84:87]
    ds_write2st64_b32 v112, v72, v73 offset0:0 offset1:37
    v_mfma_f32_16x16x32_bf16 v[88:91], a[192:195], a[172:175], v[88:91]
    v_perm_b32 v70, v101, v100, s96
    v_perm_b32 v71, v101, v100, s101
    v_mfma_f32_16x16x32_bf16 v[76:79], a[196:199], a[188:191], v[76:79]
    ds_write2st64_b32 v113, v70, v71 offset0:12 offset1:28
    buffer_load_dwordx4 v11, s[56:59], s26 offen offset:3072 lds
    v_mfma_f32_16x16x32_bf16 v[88:91], a[200:203], a[164:167], v[88:91]
    s_waitcnt lgkmcnt(0)
    s_barrier
    ds_read_b128 v[16:19], v14 offset:0
    ds_read_b128 v[20:23], v15 offset:1536
    ds_read_b128 v[24:27], v14 offset:512
    ds_read_b128 v[28:31], v15 offset:1024
    ds_read_b128 v[32:35], v14 offset:1024
    ds_read_b128 v[36:39], v15 offset:512
    ds_read_b128 v[40:43], v14 offset:1536
    ds_read_b128 v[44:47], v15 offset:0
    ds_read_b128 v[92:95], v117 offset:0
    ds_read_b128 v[96:99], v116 offset:2048
    v_mfma_f32_16x16x32_bf16 v[148:151], v[144:147], v[224:227], v[148:151]
    v_mfma_f32_16x16x32_bf16 v[148:151], v[144:147], v[228:231], v[148:151]
    v_mfma_f32_16x16x32_bf16 v[148:151], v[144:147], v[232:235], v[148:151]
    v_mfma_f32_16x16x32_bf16 v[148:151], v[144:147], v[236:239], v[148:151]
    s_waitcnt vmcnt(9)
    ds_read_b64_tr_b16 a[0:1], v13 offset:0
    s_waitcnt lgkmcnt(9)
    v_mfma_f32_16x16x32_bf16 v[76:79], v[16:19], v[20:23], v[76:79]
    ds_read_b128 a[160:163], v14 offset:64
    ds_read_b128 a[164:167], v15 offset:1600
    ds_read_b64_tr_b16 a[2:3], v13 offset:1024
    s_waitcnt lgkmcnt(11)
    v_mfma_f32_16x16x32_bf16 v[80:83], v[24:27], v[20:23], v[80:83]
    ds_read_b128 a[168:171], v14 offset:576
    ds_read_b64_tr_b16 a[4:5], v13 offset:512
    s_waitcnt lgkmcnt(12)
    v_mfma_f32_16x16x32_bf16 v[80:83], v[16:19], v[28:31], v[80:83]
    ds_read_b128 a[172:175], v15 offset:1088
    s_waitcnt lgkmcnt(7)
    ds_read_b64_tr_b16 a[6:7], v13 offset:1536
    v_mfma_f32_16x16x32_bf16 v[84:87], v[24:27], v[28:31], v[84:87]
    ds_read_b128 a[176:179], v14 offset:1088
    v_and_b32 v101, s70, v95
    ds_read_b64_tr_b16 a[8:9], v13 offset:2048
    v_mfma_f32_16x16x32_bf16 v[84:87], v[32:35], v[20:23], v[84:87]
    ds_read_b128 a[180:183], v15 offset:576
    v_lshlrev_b32_e64 v100, 16, v95
    ds_read_b64_tr_b16 a[10:11], v13 offset:3072
    v_mfma_f32_16x16x32_bf16 v[88:91], v[32:35], v[28:31], v[88:91]
    ds_read_b128 a[184:187], v14 offset:1600
    v_mul_f32_e64 v100, v100, v118
    ds_read_b64_tr_b16 a[12:13], v13 offset:2560
    v_mfma_f32_16x16x32_bf16 v[84:87], v[16:19], v[36:39], v[84:87]
    ds_read_b128 a[188:191], v15 offset:64
    v_mul_f32_e64 v101, v101, v118
    ds_read_b64_tr_b16 a[14:15], v13 offset:3584
    v_mfma_f32_16x16x32_bf16 v[88:91], v[24:27], v[36:39], v[88:91]
    v_cvt_pk_bf16_f32 v102, v101, v100
    v_and_b32_e64 v61, s70, v102
    v_mfma_f32_16x16x32_bf16 v[88:91], v[40:43], v[20:23], v[88:91]
    v_lshlrev_b32 v60, 16, v102
    v_and_b32 v69, s70, v96
    v_mfma_f32_16x16x32_bf16 v[88:91], v[16:19], v[44:47], v[88:91]
    v_lshlrev_b32 v68, 16, v96
    v_and_b32_e64 v101, s70, v94
    s_waitcnt lgkmcnt(7)
    v_mfma_f32_16x16x32_bf16 v[76:79], a[160:163], a[164:167], v[76:79]
    ds_read_b128 v[16:19], v14 offset:128
    ds_read_b128 v[20:23], v15 offset:1664
    v_lshlrev_b32_e64 v100, 16, v94
    v_mfma_f32_16x16x32_bf16 v[80:83], a[168:171], a[164:167], v[80:83]
    ds_read_b128 v[24:27], v14 offset:640
    v_mul_f32_e64 v100, v100, v118
    v_mfma_f32_16x16x32_bf16 v[80:83], a[160:163], a[172:175], v[80:83]
    ds_read_b128 v[28:31], v15 offset:1152
    v_mul_f32_e64 v101, v101, v118
    v_mfma_f32_16x16x32_bf16 v[84:87], a[168:171], a[172:175], v[84:87]
    ds_read_b128 v[32:35], v14 offset:1152
    v_cvt_pk_bf16_f32 v102, v101, v100
    v_mfma_f32_16x16x32_bf16 v[84:87], a[176:179], a[164:167], v[84:87]
    ds_read_b128 v[36:39], v15 offset:640
    v_and_b32_e64 v63, s70, v102
    v_mfma_f32_16x16x32_bf16 v[88:91], a[176:179], a[172:175], v[88:91]
    ds_read_b128 v[40:43], v14 offset:1664
    v_lshlrev_b32 v62, 16, v102
    s_waitcnt lgkmcnt(8)
    v_mfma_f32_16x16x32_bf16 v[84:87], a[160:163], a[180:183], v[84:87]
    ds_read_b128 v[44:47], v15 offset:128
    v_and_b32_e64 v71, s70, v97
    v_mfma_f32_16x16x32_bf16 v[88:91], a[168:171], a[180:183], v[88:91]
    v_lshlrev_b32 v70, 16, v97
    v_and_b32 v101, s70, v93
    v_mfma_f32_16x16x32_bf16 v[88:91], a[184:187], a[164:167], v[88:91]
    v_lshlrev_b32 v100, 16, v93
    v_mul_f32 v100, v100, v118
    v_mfma_f32_16x16x32_bf16 v[88:91], a[160:163], a[188:191], v[88:91]
    v_mul_f32_e64 v101, v101, v118
    v_cvt_pk_bf16_f32 v102, v101, v100
    s_waitcnt lgkmcnt(3)
    v_mfma_f32_16x16x32_bf16 v[76:79], v[16:19], v[20:23], v[76:79]
    ds_read_b128 a[160:163], v14 offset:192
    ds_read_b128 a[164:167], v15 offset:1728
    v_and_b32 v65, s70, v102
    s_mov_b32 m0, s38
    s_mov_b32 s100, s92
    buffer_load_dwordx4 v1, s[44:47], s100 offen offset:0 sc1 lds
    v_mfma_f32_16x16x32_bf16 v[80:83], v[24:27], v[20:23], v[80:83]
    ds_read_b128 a[168:171], v14 offset:704
    v_lshlrev_b32_e64 v64, 16, v102
    v_mfma_f32_16x16x32_bf16 v[80:83], v[16:19], v[28:31], v[80:83]
    ds_read_b128 a[172:175], v15 offset:1216
    v_and_b32_e64 v73, s70, v98
    v_mfma_f32_16x16x32_bf16 v[84:87], v[24:27], v[28:31], v[84:87]
    ds_read_b128 a[176:179], v14 offset:1216
    v_lshlrev_b32_e64 v72, 16, v98
    buffer_load_dwordx4 v1, s[44:47], s100 offen offset:1024 sc1 lds
    v_mfma_f32_16x16x32_bf16 v[84:87], v[32:35], v[20:23], v[84:87]
    ds_read_b128 a[180:183], v15 offset:704
    v_and_b32_e64 v101, s70, v92
    v_mfma_f32_16x16x32_bf16 v[88:91], v[32:35], v[28:31], v[88:91]
    ds_read_b128 a[184:187], v14 offset:1728
    v_lshlrev_b32 v100, 16, v92
    s_waitcnt lgkmcnt(7)
    v_mfma_f32_16x16x32_bf16 v[84:87], v[16:19], v[36:39], v[84:87]
    ds_read_b128 a[188:191], v15 offset:192
    v_mul_f32_e64 v100, v100, v118
    buffer_load_dwordx4 v1, s[44:47], s100 offen offset:2048 sc1 lds
    v_mfma_f32_16x16x32_bf16 v[88:91], v[24:27], v[36:39], v[88:91]
    v_mul_f32_e64 v101, v101, v118
    v_cvt_pk_bf16_f32 v102, v101, v100
    v_mfma_f32_16x16x32_bf16 v[88:91], v[40:43], v[20:23], v[88:91]
    v_and_b32 v67, s70, v102
    v_lshlrev_b32 v66, 16, v102
    v_mfma_f32_16x16x32_bf16 v[88:91], v[16:19], v[44:47], v[88:91]
    v_and_b32 v75, s70, v99
    v_lshlrev_b32_e64 v74, 16, v99
    s_waitcnt lgkmcnt(3)
    v_mfma_f32_16x16x32_bf16 v[76:79], a[160:163], a[164:167], v[76:79]
    s_or_b32 s10, s2, s3
    s_cbranch_scc0 Lep
Lep_ret:
    buffer_load_dwordx4 v1, s[44:47], s100 offen offset:3072 sc1 lds
    v_mfma_f32_16x16x32_bf16 v[80:83], a[168:171], a[164:167], v[80:83]
    v_mov_b32 v154, 0
    v_mov_b32 v155, 0
    v_mfma_f32_16x16x32_bf16 v[80:83], a[160:163], a[172:175], v[80:83]
    v_mfma_f32_16x16x32_bf16 v[84:87], a[168:171], a[172:175], v[84:87]
    s_waitcnt vmcnt(9)
    ds_read_b64_tr_b16 a[16:17], v13 offset:4096
    v_mfma_f32_16x16x32_bf16 v[84:87], a[176:179], a[164:167], v[84:87]
    ds_read_b64_tr_b16 a[18:19], v13 offset:5120
    ds_read_b64_tr_b16 a[20:21], v13 offset:4608
    v_mfma_f32_16x16x32_bf16 v[88:91], a[176:179], a[172:175], v[88:91]
    ds_read_b64_tr_b16 a[22:23], v13 offset:5632
    ds_read_b64_tr_b16 a[24:25], v13 offset:6144
    s_waitcnt lgkmcnt(5)
    v_mfma_f32_16x16x32_bf16 v[84:87], a[160:163], a[180:183], v[84:87]
    ds_read_b64_tr_b16 a[26:27], v13 offset:7168
    ds_read_b64_tr_b16 a[28:29], v13 offset:6656
    v_mfma_f32_16x16x32_bf16 v[88:91], a[168:171], a[180:183], v[88:91]
    ds_read_b64_tr_b16 a[30:31], v13 offset:7680
    v_mfma_f32_16x16x32_bf16 v[88:91], a[184:187], a[164:167], v[88:91]
    v_mfma_f32_16x16x32_bf16 v[88:91], a[160:163], a[188:191], v[88:91]
    s_nop 5
    ds_write_b128 v114, v[76:79] offset:16384
    ds_write_b128 v114, v[80:83] offset:17408
    ds_write_b128 v114, v[84:87] offset:18432
    ds_write_b128 v114, v[88:91] offset:19456
    s_waitcnt lgkmcnt(4)
    s_mov_b32 m0, s39
    s_mov_b32 s100, s93
    buffer_load_dwordx4 v1, s[44:47], s100 offen offset:0 sc1 lds
    v_mfma_f32_16x16x32_bf16 v[148:151], v[144:147], v[240:243], v[148:151]
    s_waitcnt vmcnt(5)
    ds_read_b64_tr_b16 a[32:33], v13 offset:8192
    v_mfma_f32_16x16x32_bf16 v[148:151], v[144:147], v[244:247], v[148:151]
    ds_read_b64_tr_b16 a[34:35], v13 offset:9216
    ds_read_b64_tr_b16 a[36:37], v13 offset:8704
    v_mfma_f32_16x16x32_bf16 v[148:151], v[144:147], v[248:251], v[148:151]
    ds_read_b64_tr_b16 a[38:39], v13 offset:9728
    ds_read_b64_tr_b16 a[40:41], v13 offset:10240
    buffer_load_dwordx4 v1, s[44:47], s100 offen offset:1024 sc1 lds
    v_mfma_f32_16x16x32_bf16 v[148:151], v[144:147], v[252:255], v[148:151]
    ds_read_b64_tr_b16 a[42:43], v13 offset:11264
    ds_read_b64_tr_b16 a[44:45], v13 offset:10752
    v_mfma_f32_16x16x32_bf16 v[148:151], v[144:147], a[224:227], v[148:151]
    s_waitcnt lgkmcnt(7)
    s_barrier
    ds_read_b128 v[16:19], v115 offset:16384
    ds_read_b128 v[20:23], v119 offset:16384
    ds_read_b128 v[24:27], v115 offset:20480
    ds_read_b128 v[28:31], v119 offset:20480
    buffer_load_dwordx4 v1, s[44:47], s100 offen offset:2048 sc1 lds
    v_mfma_f32_16x16x32_bf16 v[148:151], v[144:147], a[228:231], v[148:151]
    ds_read_b64_tr_b16 a[46:47], v13 offset:11776
    v_mfma_f32_16x16x32_bf16 v[148:151], v[144:147], a[232:235], v[148:151]
    v_mfma_f32_16x16x32_bf16 v[148:151], v[144:147], a[236:239], v[148:151]
    buffer_load_dwordx4 v1, s[44:47], s100 offen offset:3072 sc1 lds
    v_mfma_f32_16x16x32_bf16 v[148:151], v[144:147], a[240:243], v[148:151]
    v_mfma_f32_16x16x32_bf16 v[148:151], v[144:147], a[244:247], v[148:151]
    s_waitcnt lgkmcnt(1)
    v_pk_add_f32 v[16:17], v[16:17], v[24:25]
    v_pk_add_f32 v[16:17], v[16:17], v[60:61]
    v_cvt_pk_bf16_f32 v34, v16, v17
    v_and_b32 v33, s70, v34
    v_lshlrev_b32 v32, 16, v34
    v_pk_add_f32 v[32:33], v[32:33], v[68:69]
    v_cvt_pk_bf16_f32 v36, v32, v33
    v_pk_add_f32 v[18:19], v[18:19], v[26:27]
    v_pk_add_f32 v[18:19], v[18:19], v[62:63]
    v_cvt_pk_bf16_f32 v34, v18, v19
    v_and_b32 v33, s70, v34
    v_lshlrev_b32 v32, 16, v34
    v_pk_add_f32 v[32:33], v[32:33], v[70:71]
    v_cvt_pk_bf16_f32 v37, v32, v33
    v_pk_add_f32 v[20:21], v[20:21], v[28:29]
    v_pk_add_f32 v[20:21], v[20:21], v[64:65]
    v_cvt_pk_bf16_f32 v34, v20, v21
    v_and_b32 v33, s70, v34
    s_waitcnt lgkmcnt(0)
    s_mov_b32 m0, s40
    s_mov_b32 s100, s94
    buffer_load_dwordx4 v1, s[44:47], s100 offen offset:0 sc1 lds
    v_lshlrev_b32_e64 v32, 16, v34
    v_pk_add_f32 v[32:33], v[32:33], v[72:73]
    v_cvt_pk_bf16_f32 v38, v32, v33
    v_pk_add_f32 v[22:23], v[22:23], v[30:31]
    v_pk_add_f32 v[22:23], v[22:23], v[66:67]
    v_cvt_pk_bf16_f32 v34, v22, v23
    v_and_b32 v33, s70, v34
    v_lshlrev_b32 v32, 16, v34
    v_pk_add_f32 v[32:33], v[32:33], v[74:75]
    v_cvt_pk_bf16_f32 v39, v32, v33
    buffer_store_dwordx4 v[36:39], v2, s[44:47], s43 offen sc1
    v_add_u32 v141, 3670016, v1
    v_mfma_f32_16x16x32_bf16 v[148:151], v[144:147], a[248:251], v[148:151]
    v_mfma_f32_16x16x32_bf16 v[148:151], v[144:147], a[252:255], v[148:151]
    buffer_load_dwordx4 v1, s[44:47], s100 offen offset:1024 sc1 lds
    buffer_load_dwordx4 v1, s[44:47], s100 offen offset:2048 sc1 lds
    buffer_load_dwordx4 v1, s[44:47], s100 offen offset:3072 sc1 lds
    s_waitcnt vmcnt(9)
    ds_read_b64_tr_b16 v[36:37], v13 offset:0
    ds_read_b64_tr_b16 v[38:39], v13 offset:512
    ds_read_b64_tr_b16 v[40:41], v13 offset:1024
    ds_read_b64_tr_b16 v[42:43], v13 offset:1536
    ds_read_b64_tr_b16 v[44:45], v13 offset:2048
    ds_read_b64_tr_b16 v[46:47], v13 offset:2560
    ds_read_b64_tr_b16 v[134:135], v13 offset:3072
    ds_read_b64_tr_b16 v[136:137], v13 offset:3584
    s_mov_b32 m0, s41
    s_mov_b32 s100, s95
    buffer_load_dwordx4 v1, s[44:47], s100 offen offset:0 sc1 lds
    buffer_load_dwordx4 v1, s[44:47], s100 offen offset:1024 sc1 lds
    s_waitcnt lgkmcnt(6)
    v_mfma_f32_16x16x32_bf16 v[156:159], v[144:147], v[36:39], 0
    s_waitcnt lgkmcnt(4)
    v_mfma_f32_16x16x32_bf16 v[156:159], v[144:147], v[40:43], v[156:159]
    s_waitcnt lgkmcnt(2)
    v_mfma_f32_16x16x32_bf16 v[156:159], v[144:147], v[44:47], v[156:159]
    s_waitcnt lgkmcnt(0)
    v_mfma_f32_16x16x32_bf16 v[156:159], v[144:147], v[134:137], v[156:159]
    buffer_load_dwordx4 v1, s[44:47], s100 offen offset:2048 sc1 lds
    s_nop 7
    v_cmp_u_f32_e64 vcc, v156, v157
    s_cbranch_vccnz Lhs_0
Lhs_0_ret:
    s_barrier
    v_mfma_f32_32x32x16_bf16 v[48:63], v[160:163], v[36:39], 0
    ds_read_b64_tr_b16 v[32:33], v5 offset:0
    ds_read_b64_tr_b16 v[34:35], v5 offset:512
    buffer_load_dwordx4 v1, s[44:47], s100 offen offset:3072 sc1 lds
    v_cndmask_b32 v64, v148, v149, s[70:71]
    v_cmp_gt_u32 s[98:99], 32, v12
    v_mfma_f32_32x32x16_bf16 v[48:63], v[164:167], v[40:43], v[48:63]
    ds_read_b64_tr_b16 v[16:17], v5 offset:1024
    ds_read_b64_tr_b16 v[18:19], v5 offset:1536
    v_mov_b32 v150, 0
    v_mov_b32 v151, 0
    v_cndmask_b32 v64, 0, v64, s[98:99]
    v_mfma_f32_32x32x16_bf16 v[48:63], v[168:171], v[44:47], v[48:63]
    ds_read_b64_tr_b16 v[20:21], v5 offset:2048
    ds_read_b64_tr_b16 v[22:23], v5 offset:2560
    s_mov_b32 m0, s48
    s_nop 0
    buffer_load_dwordx4 v8, s[56:59], s27 offen offset:0 lds
    v_mfma_f32_32x32x16_bf16 v[48:63], v[172:175], v[134:137], v[48:63]
    ds_read_b64_tr_b16 v[24:25], v5 offset:3072
    ds_read_b64_tr_b16 v[26:27], v5 offset:3584
    v_cvt_pk_bf16_f32 v148, v64, v64
    v_lshlrev_b32 v65, 16, v148
    s_waitcnt lgkmcnt(6)
    v_mfma_f32_32x32x16_bf16 v[48:63], v[176:179], v[32:35], v[48:63]
    ds_read_b64_tr_b16 v[28:29], v6 offset:0
    ds_read_b64_tr_b16 v[30:31], v6 offset:512
    s_waitcnt vmcnt(10)
    ds_read_b64_tr_b16 v[36:37], v13 offset:4096
    ds_read_b64_tr_b16 v[38:39], v13 offset:4608
    buffer_load_dwordx4 v9, s[56:59], s27 offen offset:1024 lds
    s_waitcnt lgkmcnt(8)
    v_mfma_f32_32x32x16_bf16 v[48:63], v[180:183], v[16:19], v[48:63]
    ds_read_b64_tr_b16 v[32:33], v6 offset:1024
    ds_read_b64_tr_b16 v[34:35], v6 offset:1536
    ds_read_b64_tr_b16 v[40:41], v13 offset:5120
    ds_read_b64_tr_b16 v[42:43], v13 offset:5632
    s_waitcnt lgkmcnt(10)
    v_mfma_f32_32x32x16_bf16 v[48:63], v[184:187], v[20:23], v[48:63]
    ds_read_b64_tr_b16 v[16:17], v6 offset:2048
    ds_read_b64_tr_b16 v[18:19], v6 offset:2560
    ds_read_b64_tr_b16 v[44:45], v13 offset:6144
    ds_read_b64_tr_b16 v[46:47], v13 offset:6656
    buffer_load_dwordx4 v10, s[56:59], s27 offen offset:2048 lds
    s_waitcnt lgkmcnt(12)
    v_mfma_f32_32x32x16_bf16 v[48:63], v[188:191], v[24:27], v[48:63]
    ds_read_b64_tr_b16 v[20:21], v6 offset:3072
    ds_read_b64_tr_b16 v[22:23], v6 offset:3584
    ds_read_b64_tr_b16 v[134:135], v13 offset:7168
    ds_read_b64_tr_b16 v[136:137], v13 offset:7680
    s_waitcnt lgkmcnt(14)
    v_mfma_f32_32x32x16_bf16 v[48:63], v[192:195], v[28:31], v[48:63]
    ds_read_b64_tr_b16 v[24:25], v7 offset:0
    ds_read_b64_tr_b16 v[26:27], v7 offset:512
    buffer_load_dwordx4 v11, s[56:59], s27 offen offset:3072 lds
    v_sub_f32_e64 v64, v64, v65
    s_waitcnt lgkmcnt(14)
    v_mfma_f32_16x16x32_bf16 v[130:133], v[144:147], v[36:39], v[156:159]
    s_waitcnt lgkmcnt(12)
    v_mfma_f32_32x32x16_bf16 v[48:63], v[196:199], v[32:35], v[48:63]
    ds_read_b64_tr_b16 v[28:29], v7 offset:1024
    ds_read_b64_tr_b16 v[30:31], v7 offset:1536
    v_cvt_pk_bf16_f32 v148, v65, v64
    s_or_b32 m0, s41, 65536
    s_nop 0
    buffer_load_dwordx4 v8, s[56:59], s28 offen offset:0 lds
    s_waitcnt lgkmcnt(12)
    v_mfma_f32_16x16x32_bf16 v[130:133], v[144:147], v[40:43], v[130:133]
    s_waitcnt lgkmcnt(10)
    v_mfma_f32_32x32x16_bf16 v[48:63], v[200:203], v[16:19], v[48:63]
    ds_read_b64_tr_b16 v[32:33], v7 offset:2048
    ds_read_b64_tr_b16 v[34:35], v7 offset:2560
    v_and_b32 v65, s70, v148
    v_sub_f32_e64 v64, v64, v65
    s_waitcnt lgkmcnt(10)
    v_mfma_f32_16x16x32_bf16 v[130:133], v[144:147], v[44:47], v[130:133]
    buffer_load_dwordx4 v9, s[56:59], s28 offen offset:1024 lds
    s_waitcnt lgkmcnt(8)
    v_mfma_f32_32x32x16_bf16 v[48:63], v[204:207], v[20:23], v[48:63]
    ds_read_b64_tr_b16 v[16:17], v7 offset:3072
    ds_read_b64_tr_b16 v[18:19], v7 offset:3584
    v_cvt_pk_bf16_f32 v149, v64, 0
    s_mov_b32 s97, 0
    s_waitcnt lgkmcnt(8)
    v_mfma_f32_16x16x32_bf16 v[130:133], v[144:147], v[134:137], v[130:133]
    s_waitcnt lgkmcnt(6)
    v_mfma_f32_32x32x16_bf16 v[48:63], v[208:211], v[24:27], v[48:63]
    buffer_load_dwordx4 v10, s[56:59], s28 offen offset:2048 lds
    s_mov_b32 s96, 0x80008000
    s_waitcnt lgkmcnt(4)
    v_mfma_f32_32x32x16_bf16 v[48:63], v[212:215], v[28:31], v[48:63]
    s_nop 1
    v_cmp_u_f32 vcc, v130, v131
    s_cbranch_vccnz Lhs_1
Lhs_1_ret:
    v_cndmask_b32 v130, v130, v131, s[70:71]
    ds_write_b32 v129, v130 offset:0
    buffer_load_dwordx4 v11, s[56:59], s28 offen offset:3072 lds
    s_waitcnt lgkmcnt(3)
    v_mfma_f32_32x32x16_bf16 v[48:63], v[216:219], v[32:35], v[48:63]
    s_waitcnt lgkmcnt(1)
    v_mfma_f32_32x32x16_bf16 v[48:63], v[220:223], v[16:19], v[48:63]
    s_waitcnt lgkmcnt(0)
    s_barrier
    s_or_b32 m0, s40, 65536
    s_nop 0
    buffer_load_dwordx4 v8, s[56:59], s29 offen offset:0 lds
    v_mfma_f32_32x32x16_bf16 v[48:63], v[224:227], v[36:39], v[48:63]
    ds_read_b64_tr_b16 v[20:21], v5 offset:4096
    ds_read_b64_tr_b16 v[22:23], v5 offset:4608
    ds_read2st64_b32 v[130:131], v138 offset0:0 offset1:1
    v_mfma_f32_32x32x16_bf16 v[48:63], v[228:231], v[40:43], v[48:63]
    ds_read_b64_tr_b16 v[24:25], v5 offset:5120
    ds_read_b64_tr_b16 v[26:27], v5 offset:5632
    ds_read2st64_b32 v[132:133], v138 offset0:2 offset1:3
    buffer_load_dwordx4 v9, s[56:59], s29 offen offset:1024 lds
    v_mfma_f32_32x32x16_bf16 v[48:63], v[232:235], v[44:47], v[48:63]
    ds_read_b64_tr_b16 v[28:29], v5 offset:6144
    ds_read_b64_tr_b16 v[30:31], v5 offset:6656
    v_mfma_f32_32x32x16_bf16 v[48:63], v[236:239], v[134:137], v[48:63]
    ds_read_b64_tr_b16 v[32:33], v5 offset:7168
    ds_read_b64_tr_b16 v[34:35], v5 offset:7680
    buffer_load_dwordx4 v10, s[56:59], s29 offen offset:2048 lds
    s_waitcnt lgkmcnt(8)
    v_mfma_f32_32x32x16_bf16 v[48:63], v[240:243], v[20:23], v[48:63]
    ds_read_b64_tr_b16 v[16:17], v6 offset:4096
    ds_read_b64_tr_b16 v[18:19], v6 offset:4608
    s_waitcnt vmcnt(15)
    ds_read_b64_tr_b16 v[36:37], v13 offset:8192
    ds_read_b64_tr_b16 v[38:39], v13 offset:8704
    s_waitcnt lgkmcnt(9)
    v_mfma_f32_32x32x16_bf16 v[48:63], v[244:247], v[24:27], v[48:63]
    ds_read_b64_tr_b16 v[20:21], v6 offset:5120
    ds_read_b64_tr_b16 v[22:23], v6 offset:5632
    ds_read_b64_tr_b16 v[40:41], v13 offset:9216
    ds_read_b64_tr_b16 v[42:43], v13 offset:9728
    buffer_load_dwordx4 v11, s[56:59], s29 offen offset:3072 lds
    s_waitcnt lgkmcnt(10)
    v_mfma_f32_32x32x16_bf16 v[48:63], v[248:251], v[28:31], v[48:63]
    ds_read_b64_tr_b16 v[24:25], v6 offset:6144
    ds_read_b64_tr_b16 v[26:27], v6 offset:6656
    ds_read_b64_tr_b16 v[44:45], v13 offset:10240
    ds_read_b64_tr_b16 v[46:47], v13 offset:10752
    s_waitcnt lgkmcnt(12)
    v_mfma_f32_32x32x16_bf16 v[48:63], v[252:255], v[32:35], v[48:63]
    ds_read_b64_tr_b16 v[28:29], v6 offset:7168
    ds_read_b64_tr_b16 v[30:31], v6 offset:7680
    ds_read_b64_tr_b16 v[134:135], v13 offset:11264
    ds_read_b64_tr_b16 v[136:137], v13 offset:11776
    s_or_b32 m0, s38, 65536
    s_add_u32 s100, s92, 0x100000
    buffer_load_dwordx4 v1, s[44:47], s100 offen offset:0 sc1 lds
    s_waitcnt lgkmcnt(14)
    v_mfma_f32_32x32x16_bf16 v[48:63], a[224:227], v[16:19], v[48:63]
    ds_read_b64_tr_b16 v[32:33], v7 offset:4096
    ds_read_b64_tr_b16 v[34:35], v7 offset:4608
    s_waitcnt lgkmcnt(14)
    v_mfma_f32_16x16x32_bf16 v[156:159], v[144:147], v[36:39], 0
    s_waitcnt lgkmcnt(12)
    v_mfma_f32_32x32x16_bf16 v[48:63], a[228:231], v[20:23], v[48:63]
    ds_read_b64_tr_b16 v[16:17], v7 offset:5120
    ds_read_b64_tr_b16 v[18:19], v7 offset:5632
    buffer_load_dwordx4 v1, s[44:47], s100 offen offset:1024 sc1 lds
    s_waitcnt lgkmcnt(12)
    v_mfma_f32_16x16x32_bf16 v[156:159], v[144:147], v[40:43], v[156:159]
    s_waitcnt lgkmcnt(10)
    v_mfma_f32_32x32x16_bf16 v[48:63], a[232:235], v[24:27], v[48:63]
    ds_read_b64_tr_b16 v[20:21], v7 offset:6144
    ds_read_b64_tr_b16 v[22:23], v7 offset:6656
    s_waitcnt lgkmcnt(10)
    v_mfma_f32_16x16x32_bf16 v[156:159], v[144:147], v[44:47], v[156:159]
    buffer_load_dwordx4 v1, s[44:47], s100 offen offset:2048 sc1 lds
    s_waitcnt lgkmcnt(8)
    v_mfma_f32_32x32x16_bf16 v[48:63], a[236:239], v[28:31], v[48:63]
    ds_read_b64_tr_b16 v[24:25], v7 offset:7168
    ds_read_b64_tr_b16 v[26:27], v7 offset:7680
    s_waitcnt lgkmcnt(8)
    v_mfma_f32_16x16x32_bf16 v[156:159], v[144:147], v[134:137], v[156:159]
    s_waitcnt lgkmcnt(6)
    v_mfma_f32_32x32x16_bf16 v[48:63], a[240:243], v[32:35], v[48:63]
    v_add_f32 v130, v130, v131
    v_add_f32 v132, v132, v133
    v_add_f32 v130, v130, v132
    v_mul_f32 v130, 0xbb000000, v130
    buffer_load_dwordx4 v1, s[44:47], s100 offen offset:3072 sc1 lds
    s_waitcnt vmcnt(12)
    ds_read_b64_tr_b16 a[48:49], v140 offset:0
    s_waitcnt lgkmcnt(5)
    v_mfma_f32_32x32x16_bf16 v[48:63], a[244:247], v[16:19], v[48:63]
    v_cmp_u_f32 vcc, v156, v157
    s_cbranch_vccnz Lhs_2
Lhs_2_ret:
    v_cvt_pk_bf16_f32 v152, v130, v130
    v_cvt_pk_bf16_f32 v153, v130, v130
    ds_read_b64_tr_b16 a[50:51], v140 offset:1024
    s_waitcnt lgkmcnt(4)
    v_mfma_f32_32x32x16_bf16 v[48:63], a[248:251], v[20:23], v[48:63]
    s_or_b32 m0, s39, 65536
    s_add_u32 s100, s93, 0x100000
    buffer_load_dwordx4 v1, s[44:47], s100 offen offset:0 sc1 lds
    ds_read_b64_tr_b16 a[52:53], v140 offset:512
    ds_read_b64_tr_b16 a[54:55], v140 offset:1536
    v_mfma_f32_32x32x16_bf16 v[48:63], v[148:151], v[152:155], v[48:63]
    ds_read_b64_tr_b16 a[56:57], v140 offset:2048
    ds_read_b64_tr_b16 a[58:59], v140 offset:3072
    ds_read_b64_tr_b16 a[60:61], v140 offset:2560
    s_waitcnt lgkmcnt(7)
    v_mfma_f32_32x32x16_bf16 v[48:63], a[252:255], v[24:27], v[48:63]
    s_barrier
    buffer_load_dwordx4 v1, s[44:47], s100 offen offset:1024 sc1 lds
    ds_read_b64_tr_b16 a[62:63], v140 offset:3584
    v_mfma_f32_32x32x16_bf16 v[64:79], v[160:163], v[36:39], 0
    ds_read_b64_tr_b16 v[28:29], v5 offset:8192
    ds_read_b64_tr_b16 v[30:31], v5 offset:8704
    v_mfma_f32_32x32x16_bf16 v[64:79], v[164:167], v[40:43], v[64:79]
    ds_read_b64_tr_b16 v[32:33], v5 offset:9216
    ds_read_b64_tr_b16 v[34:35], v5 offset:9728
    s_nop 2
    v_cvt_pk_bf16_f32 v48, v48, v49
    v_pk_max_i16 v48, v48, 0
    v_or_b32_e64 v48, v48, v142
    buffer_load_dwordx4 v1, s[44:47], s100 offen offset:2048 sc1 lds
    v_mfma_f32_32x32x16_bf16 v[64:79], v[168:171], v[44:47], v[64:79]
    ds_read_b64_tr_b16 v[16:17], v5 offset:10240
    ds_read_b64_tr_b16 v[18:19], v5 offset:10752
    v_cvt_pk_bf16_f32 v49, v50, v51
    v_pk_max_i16 v49, v49, 0
    v_or_b32_e64 v49, v49, v142
    v_cvt_pk_bf16_f32 v50, v52, v53
    v_mfma_f32_32x32x16_bf16 v[64:79], v[172:175], v[134:137], v[64:79]
    ds_read_b64_tr_b16 v[20:21], v5 offset:11264
    ds_read_b64_tr_b16 v[22:23], v5 offset:11776
    v_pk_max_i16 v50, v50, 0
    v_or_b32_e64 v50, v50, v142
    v_cvt_pk_bf16_f32 v51, v54, v55
    v_pk_max_i16 v51, v51, 0
    buffer_load_dwordx4 v1, s[44:47], s100 offen offset:3072 sc1 lds
    s_waitcnt vmcnt(12)
    ds_read_b64_tr_b16 a[64:65], v139 offset:12288
    s_waitcnt lgkmcnt(7)
    v_mfma_f32_32x32x16_bf16 v[64:79], v[176:179], v[28:31], v[64:79]
    ds_read_b64_tr_b16 v[24:25], v6 offset:8192
    ds_read_b64_tr_b16 v[26:27], v6 offset:8704
    ds_read_b64_tr_b16 v[36:37], v13 offset:12288
    ds_read_b64_tr_b16 v[38:39], v13 offset:12800
    v_or_b32_e64 v51, v51, v142
    buffer_store_dwordx4 v[48:51], v1, s[64:67], s86 offen offset:0 sc1
    v_cvt_pk_bf16_f32 v56, v56, v57
    v_pk_max_i16 v56, v56, 0
    s_waitcnt lgkmcnt(9)
    v_mfma_f32_32x32x16_bf16 v[64:79], v[180:183], v[32:35], v[64:79]
    ds_read_b64_tr_b16 v[28:29], v6 offset:9216
    ds_read_b64_tr_b16 v[30:31], v6 offset:9728
    ds_read_b64_tr_b16 v[40:41], v13 offset:13312
    ds_read_b64_tr_b16 v[42:43], v13 offset:13824
    v_or_b32 v56, v56, v142
    v_cvt_pk_bf16_f32 v57, v58, v59
    v_pk_max_i16 v57, v57, 0
    v_or_b32_e64 v57, v57, v142
    s_mov_b32 m0, s48
    s_nop 0
    buffer_load_dwordx4 v8, s[56:59], s30 offen offset:0 lds
    s_waitcnt lgkmcnt(11)
    v_mfma_f32_32x32x16_bf16 v[64:79], v[184:187], v[16:19], v[64:79]
    ds_read_b64_tr_b16 v[32:33], v6 offset:10240
    ds_read_b64_tr_b16 v[34:35], v6 offset:10752
    ds_read_b64_tr_b16 v[44:45], v13 offset:14336
    ds_read_b64_tr_b16 v[46:47], v13 offset:14848
    v_cvt_pk_bf16_f32 v58, v60, v61
    v_pk_max_i16 v58, v58, 0
    v_or_b32 v58, v58, v142
    v_cvt_pk_bf16_f32 v59, v62, v63
    s_waitcnt lgkmcnt(13)
    v_mfma_f32_32x32x16_bf16 v[64:79], v[188:191], v[20:23], v[64:79]
    ds_read_b64_tr_b16 v[16:17], v6 offset:11264
    ds_read_b64_tr_b16 v[18:19], v6 offset:11776
    ds_read_b64_tr_b16 v[134:135], v13 offset:15360
    ds_read_b64_tr_b16 v[136:137], v13 offset:15872
    v_pk_max_i16 v59, v59, 0
    v_or_b32 v59, v59, v142
    buffer_store_dwordx4 v[56:59], v1, s[64:67], s86 offen offset:1024 sc1
    s_waitcnt lgkmcnt(14)
    v_mfma_f32_32x32x16_bf16 v[64:79], v[192:195], v[24:27], v[64:79]
    ds_read_b64_tr_b16 v[20:21], v7 offset:8192
    ds_read_b64_tr_b16 v[22:23], v7 offset:8704
    ds_read_b64_tr_b16 a[66:67], v139 offset:13312
    s_waitcnt lgkmcnt(15)
    v_mfma_f32_16x16x32_bf16 v[130:133], v[144:147], v[36:39], v[156:159]
    ds_read_b64_tr_b16 a[68:69], v139 offset:12800
    s_waitcnt lgkmcnt(14)
    v_mfma_f32_32x32x16_bf16 v[64:79], v[196:199], v[28:31], v[64:79]
    ds_read_b64_tr_b16 v[24:25], v7 offset:9216
    ds_read_b64_tr_b16 v[26:27], v7 offset:9728
    buffer_load_dwordx4 v9, s[56:59], s30 offen offset:1024 lds
    ds_read_b64_tr_b16 a[70:71], v139 offset:13824
    s_waitcnt lgkmcnt(15)
    v_mfma_f32_16x16x32_bf16 v[130:133], v[144:147], v[40:43], v[130:133]
    ds_read_b64_tr_b16 a[72:73], v139 offset:14336
    s_waitcnt lgkmcnt(14)
    v_mfma_f32_32x32x16_bf16 v[64:79], v[200:203], v[32:35], v[64:79]
    ds_read_b64_tr_b16 v[28:29], v7 offset:10240
    ds_read_b64_tr_b16 v[30:31], v7 offset:10752
    ds_read_b64_tr_b16 a[74:75], v139 offset:15360
    buffer_load_dwordx4 v10, s[56:59], s30 offen offset:2048 lds
    s_waitcnt lgkmcnt(15)
    v_mfma_f32_16x16x32_bf16 v[130:133], v[144:147], v[44:47], v[130:133]
    ds_read_b64_tr_b16 a[76:77], v139 offset:14848
    s_waitcnt lgkmcnt(14)
    v_mfma_f32_32x32x16_bf16 v[64:79], v[204:207], v[16:19], v[64:79]
    ds_read_b64_tr_b16 v[32:33], v7 offset:11264
    ds_read_b64_tr_b16 v[34:35], v7 offset:11776
    ds_read_b64_tr_b16 a[78:79], v139 offset:15872
    s_waitcnt lgkmcnt(15)
    v_mfma_f32_16x16x32_bf16 v[130:133], v[144:147], v[134:137], v[130:133]
    buffer_load_dwordx4 v11, s[56:59], s30 offen offset:3072 lds
    s_waitcnt vmcnt(14)
    ds_read_b64_tr_b16 a[80:81], v139 offset:8192
    s_waitcnt lgkmcnt(14)
    v_mfma_f32_32x32x16_bf16 v[64:79], v[208:211], v[20:23], v[64:79]
    ds_read_b64_tr_b16 a[82:83], v139 offset:9216
    ds_read_b64_tr_b16 a[84:85], v139 offset:8704
    ds_read_b64_tr_b16 a[86:87], v139 offset:9728
    s_waitcnt lgkmcnt(13)
    v_mfma_f32_32x32x16_bf16 v[64:79], v[212:215], v[24:27], v[64:79]
    v_cmp_u_f32_e64 vcc, v130, v131
    s_cbranch_vccnz Lhs_3
Lhs_3_ret:
    v_cndmask_b32 v130, v130, v131, s[70:71]
    ds_write_b32 v129, v130 offset:1024
    ds_read_b64_tr_b16 a[88:89], v139 offset:10240
    s_waitcnt lgkmcnt(11)
    v_mfma_f32_32x32x16_bf16 v[64:79], v[216:219], v[28:31], v[64:79]
    ds_read_b64_tr_b16 a[90:91], v139 offset:11264
    ds_read_b64_tr_b16 a[92:93], v139 offset:10752
    ds_read_b64_tr_b16 a[94:95], v139 offset:11776
    s_waitcnt lgkmcnt(10)
    v_mfma_f32_32x32x16_bf16 v[64:79], v[220:223], v[32:35], v[64:79]
    s_waitcnt lgkmcnt(4)
    s_barrier
    v_mfma_f32_32x32x16_bf16 v[64:79], v[224:227], v[36:39], v[64:79]
    ds_read_b64_tr_b16 v[16:17], v5 offset:12288
    ds_read_b64_tr_b16 v[18:19], v5 offset:12800
    ds_read2st64_b32 v[130:131], v138 offset0:4 offset1:5
    s_mov_b32 m0, s38
    s_nop 0
    buffer_load_dwordx4 v8, s[56:59], s31 offen offset:0 lds
    v_mfma_f32_32x32x16_bf16 v[64:79], v[228:231], v[40:43], v[64:79]
    ds_read_b64_tr_b16 v[20:21], v5 offset:13312
    ds_read_b64_tr_b16 v[22:23], v5 offset:13824
    ds_read2st64_b32 v[132:133], v138 offset0:6 offset1:7
    v_mfma_f32_32x32x16_bf16 v[64:79], v[232:235], v[44:47], v[64:79]
    ds_read_b64_tr_b16 v[24:25], v5 offset:14336
    ds_read_b64_tr_b16 v[26:27], v5 offset:14848
    buffer_load_dwordx4 v9, s[56:59], s31 offen offset:1024 lds
    v_mfma_f32_32x32x16_bf16 v[64:79], v[236:239], v[134:137], v[64:79]
    ds_read_b64_tr_b16 v[28:29], v5 offset:15360
    ds_read_b64_tr_b16 v[30:31], v5 offset:15872
    s_waitcnt lgkmcnt(8)
    v_mfma_f32_32x32x16_bf16 v[64:79], v[240:243], v[16:19], v[64:79]
    ds_read_b64_tr_b16 v[32:33], v6 offset:12288
    ds_read_b64_tr_b16 v[34:35], v6 offset:12800
    s_waitcnt vmcnt(12)
    ds_read_b64_tr_b16 v[36:37], v139 offset:0
    ds_read_b64_tr_b16 v[38:39], v139 offset:512
    buffer_load_dwordx4 v10, s[56:59], s31 offen offset:2048 lds
    s_waitcnt lgkmcnt(9)
    v_mfma_f32_32x32x16_bf16 v[64:79], v[244:247], v[20:23], v[64:79]
    ds_read_b64_tr_b16 v[16:17], v6 offset:13312
    ds_read_b64_tr_b16 v[18:19], v6 offset:13824
    ds_read_b64_tr_b16 v[40:41], v139 offset:1024
    ds_read_b64_tr_b16 v[42:43], v139 offset:1536
    s_waitcnt lgkmcnt(10)
    v_mfma_f32_32x32x16_bf16 v[64:79], v[248:251], v[24:27], v[64:79]
    ds_read_b64_tr_b16 v[20:21], v6 offset:14336
    ds_read_b64_tr_b16 v[22:23], v6 offset:14848
    ds_read_b64_tr_b16 v[44:45], v139 offset:2048
    ds_read_b64_tr_b16 v[46:47], v139 offset:2560
    buffer_load_dwordx4 v11, s[56:59], s31 offen offset:3072 lds
    s_waitcnt lgkmcnt(12)
    v_mfma_f32_32x32x16_bf16 v[64:79], v[252:255], v[28:31], v[64:79]
    ds_read_b64_tr_b16 v[24:25], v6 offset:15360
    ds_read_b64_tr_b16 v[26:27], v6 offset:15872
    ds_read_b64_tr_b16 v[134:135], v139 offset:3072
    ds_read_b64_tr_b16 v[136:137], v139 offset:3584
    s_waitcnt lgkmcnt(14)
    v_mfma_f32_32x32x16_bf16 v[64:79], a[224:227], v[32:35], v[64:79]
    ds_read_b64_tr_b16 v[28:29], v7 offset:12288
    ds_read_b64_tr_b16 v[30:31], v7 offset:12800
    s_or_b32 m0, s40, 65536
    s_add_u32 s100, s94, 0x100000
    buffer_load_dwordx4 v1, s[44:47], s100 offen offset:0 sc1 lds
    s_waitcnt lgkmcnt(14)
    v_mfma_f32_16x16x32_bf16 v[156:159], v[144:147], v[36:39], 0
    s_waitcnt lgkmcnt(12)
    v_mfma_f32_32x32x16_bf16 v[64:79], a[228:231], v[16:19], v[64:79]
    ds_read_b64_tr_b16 v[32:33], v7 offset:13312
    ds_read_b64_tr_b16 v[34:35], v7 offset:13824
    s_waitcnt lgkmcnt(12)
    v_mfma_f32_16x16x32_bf16 v[156:159], v[144:147], v[40:43], v[156:159]
    buffer_load_dwordx4 v1, s[44:47], s100 offen offset:1024 sc1 lds
    s_waitcnt lgkmcnt(10)
    v_mfma_f32_32x32x16_bf16 v[64:79], a[232:235], v[20:23], v[64:79]
    ds_read_b64_tr_b16 v[16:17], v7 offset:14336
    ds_read_b64_tr_b16 v[18:19], v7 offset:14848
    s_waitcnt lgkmcnt(10)
    v_mfma_f32_16x16x32_bf16 v[156:159], v[144:147], v[44:47], v[156:159]
    s_waitcnt lgkmcnt(8)
    v_mfma_f32_32x32x16_bf16 v[64:79], a[236:239], v[24:27], v[64:79]
    ds_read_b64_tr_b16 v[20:21], v7 offset:15360
    ds_read_b64_tr_b16 v[22:23], v7 offset:15872
    buffer_load_dwordx4 v1, s[44:47], s100 offen offset:2048 sc1 lds
    s_waitcnt lgkmcnt(8)
    v_mfma_f32_16x16x32_bf16 v[156:159], v[144:147], v[134:137], v[156:159]
    s_waitcnt lgkmcnt(6)
    v_mfma_f32_32x32x16_bf16 v[64:79], a[240:243], v[28:31], v[64:79]
    v_add_u32 v5, 65536, v5
    v_add_f32 v130, v130, v131
    v_add_f32 v132, v132, v133
    v_add_f32_e64 v14, v130, v132
    v_mul_f32 v130, 0xbb000000, v14
    buffer_load_dwordx4 v1, s[44:47], s100 offen offset:3072 sc1 lds
    s_waitcnt lgkmcnt(4)
    v_mfma_f32_32x32x16_bf16 v[64:79], a[244:247], v[32:35], v[64:79]
    v_cmp_u_f32_e64 vcc, v156, v157
    s_cbranch_vccnz Lhs_4
Lhs_4_ret:
    v_add_u32 v6, 65536, v6
    v_cvt_pk_bf16_f32 v152, v130, v130
    v_cvt_pk_bf16_f32 v153, v130, v130
    s_waitcnt lgkmcnt(2)
    v_mfma_f32_32x32x16_bf16 v[64:79], a[248:251], v[16:19], v[64:79]
    v_add_u32 v7, 65536, v7
    s_or_b32 m0, s41, 65536
    s_add_u32 s100, s95, 0x100000
    buffer_load_dwordx4 v1, s[44:47], s100 offen offset:0 sc1 lds
    v_mfma_f32_32x32x16_bf16 v[64:79], v[148:151], v[152:155], v[64:79]
    s_waitcnt lgkmcnt(0)
    v_mfma_f32_32x32x16_bf16 v[64:79], a[252:255], v[20:23], v[64:79]
    s_barrier
    buffer_load_dwordx4 v1, s[44:47], s100 offen offset:1024 sc1 lds
    v_mfma_f32_32x32x16_bf16 v[48:63], v[160:163], v[36:39], 0
    ds_read_b64_tr_b16 v[24:25], v5 offset:0
    ds_read_b64_tr_b16 v[26:27], v5 offset:512
    v_mfma_f32_32x32x16_bf16 v[48:63], v[164:167], v[40:43], v[48:63]
    ds_read_b64_tr_b16 v[28:29], v5 offset:1024
    ds_read_b64_tr_b16 v[30:31], v5 offset:1536
    s_nop 3
    v_cvt_pk_bf16_f32 v64, v64, v65
    v_pk_max_i16 v64, v64, 0
    v_or_b32_e64 v64, v64, v142
    buffer_load_dwordx4 v1, s[44:47], s100 offen offset:2048 sc1 lds
    v_mfma_f32_32x32x16_bf16 v[48:63], v[168:171], v[44:47], v[48:63]
    ds_read_b64_tr_b16 v[32:33], v5 offset:2048
    ds_read_b64_tr_b16 v[34:35], v5 offset:2560
    v_cvt_pk_bf16_f32 v65, v66, v67
    v_pk_max_i16 v65, v65, 0
    v_or_b32_e64 v65, v65, v142
    v_cvt_pk_bf16_f32 v66, v68, v69
    v_mfma_f32_32x32x16_bf16 v[48:63], v[172:175], v[134:137], v[48:63]
    ds_read_b64_tr_b16 v[16:17], v5 offset:3072
    ds_read_b64_tr_b16 v[18:19], v5 offset:3584
    v_pk_max_i16 v66, v66, 0
    v_or_b32_e64 v66, v66, v142
    v_cvt_pk_bf16_f32 v67, v70, v71
    v_pk_max_i16 v67, v67, 0
    buffer_load_dwordx4 v1, s[44:47], s100 offen offset:3072 sc1 lds
    s_waitcnt vmcnt(12)
    ds_read_b64_tr_b16 a[96:97], v140 offset:0
    s_waitcnt lgkmcnt(7)
    v_mfma_f32_32x32x16_bf16 v[48:63], v[176:179], v[24:27], v[48:63]
    ds_read_b64_tr_b16 v[20:21], v6 offset:0
    ds_read_b64_tr_b16 v[22:23], v6 offset:512
    ds_read_b64_tr_b16 v[36:37], v139 offset:4096
    ds_read_b64_tr_b16 v[38:39], v139 offset:4608
    v_or_b32_e64 v67, v67, v142
    buffer_store_dwordx4 v[64:67], v1, s[64:67], s87 offen offset:0 sc1
    v_cvt_pk_bf16_f32 v72, v72, v73
    v_pk_max_i16 v72, v72, 0
    s_waitcnt lgkmcnt(9)
    v_mfma_f32_32x32x16_bf16 v[48:63], v[180:183], v[28:31], v[48:63]
    ds_read_b64_tr_b16 v[24:25], v6 offset:1024
    ds_read_b64_tr_b16 v[26:27], v6 offset:1536
    ds_read_b64_tr_b16 v[40:41], v139 offset:5120
    ds_read_b64_tr_b16 v[42:43], v139 offset:5632
    v_or_b32 v72, v72, v142
    v_cvt_pk_bf16_f32 v73, v74, v75
    v_pk_max_i16 v73, v73, 0
    v_or_b32_e64 v73, v73, v142
    s_mov_b32 m0, s39
    s_nop 0
    buffer_load_dwordx4 v8, s[56:59], s32 offen offset:0 lds
    s_waitcnt lgkmcnt(11)
    v_mfma_f32_32x32x16_bf16 v[48:63], v[184:187], v[32:35], v[48:63]
    ds_read_b64_tr_b16 v[28:29], v6 offset:2048
    ds_read_b64_tr_b16 v[30:31], v6 offset:2560
    ds_read_b64_tr_b16 v[44:45], v139 offset:6144
    ds_read_b64_tr_b16 v[46:47], v139 offset:6656
    v_cvt_pk_bf16_f32 v74, v76, v77
    v_pk_max_i16 v74, v74, 0
    v_or_b32 v74, v74, v142
    v_cvt_pk_bf16_f32 v75, v78, v79
    s_waitcnt lgkmcnt(13)
    v_mfma_f32_32x32x16_bf16 v[48:63], v[188:191], v[16:19], v[48:63]
    ds_read_b64_tr_b16 v[32:33], v6 offset:3072
    ds_read_b64_tr_b16 v[34:35], v6 offset:3584
    ds_read_b64_tr_b16 v[134:135], v139 offset:7168
    ds_read_b64_tr_b16 v[136:137], v139 offset:7680
    v_pk_max_i16 v75, v75, 0
    v_or_b32 v75, v75, v142
    buffer_store_dwordx4 v[72:75], v1, s[64:67], s87 offen offset:1024 sc1
    s_waitcnt lgkmcnt(14)
    v_mfma_f32_32x32x16_bf16 v[48:63], v[192:195], v[20:23], v[48:63]
    ds_read_b64_tr_b16 v[16:17], v7 offset:0
    ds_read_b64_tr_b16 v[18:19], v7 offset:512
    ds_read_b64_tr_b16 a[98:99], v140 offset:1024
    s_waitcnt lgkmcnt(15)
    v_mfma_f32_16x16x32_bf16 v[130:133], v[144:147], v[36:39], v[156:159]
    ds_read_b64_tr_b16 a[100:101], v140 offset:512
    s_waitcnt lgkmcnt(14)
    v_mfma_f32_32x32x16_bf16 v[48:63], v[196:199], v[24:27], v[48:63]
    ds_read_b64_tr_b16 v[20:21], v7 offset:1024
    ds_read_b64_tr_b16 v[22:23], v7 offset:1536
    buffer_load_dwordx4 v9, s[56:59], s32 offen offset:1024 lds
    ds_read_b64_tr_b16 a[102:103], v140 offset:1536
    s_waitcnt lgkmcnt(15)
    v_mfma_f32_16x16x32_bf16 v[130:133], v[144:147], v[40:43], v[130:133]
    ds_read_b64_tr_b16 a[104:105], v140 offset:2048
    s_waitcnt lgkmcnt(14)
    v_mfma_f32_32x32x16_bf16 v[48:63], v[200:203], v[28:31], v[48:63]
    ds_read_b64_tr_b16 v[24:25], v7 offset:2048
    ds_read_b64_tr_b16 v[26:27], v7 offset:2560
    ds_read_b64_tr_b16 a[106:107], v140 offset:3072
    buffer_load_dwordx4 v10, s[56:59], s32 offen offset:2048 lds
    s_waitcnt lgkmcnt(15)
    v_mfma_f32_16x16x32_bf16 v[130:133], v[144:147], v[44:47], v[130:133]
    ds_read_b64_tr_b16 a[108:109], v140 offset:2560
    s_waitcnt lgkmcnt(14)
    v_mfma_f32_32x32x16_bf16 v[48:63], v[204:207], v[32:35], v[48:63]
    ds_read_b64_tr_b16 v[28:29], v7 offset:3072
    ds_read_b64_tr_b16 v[30:31], v7 offset:3584
    ds_read_b64_tr_b16 a[110:111], v140 offset:3584
    s_waitcnt lgkmcnt(15)
    v_mfma_f32_16x16x32_bf16 v[130:133], v[144:147], v[134:137], v[130:133]
    buffer_load_dwordx4 v11, s[56:59], s32 offen offset:3072 lds
    s_waitcnt vmcnt(14)
    ds_read_b64_tr_b16 a[112:113], v13 offset:0
    s_waitcnt lgkmcnt(14)
    v_mfma_f32_32x32x16_bf16 v[48:63], v[208:211], v[16:19], v[48:63]
    ds_read_b64_tr_b16 a[114:115], v13 offset:1024
    ds_read_b64_tr_b16 a[116:117], v13 offset:512
    ds_read_b64_tr_b16 a[118:119], v13 offset:1536
    s_waitcnt lgkmcnt(13)
    v_mfma_f32_32x32x16_bf16 v[48:63], v[212:215], v[20:23], v[48:63]
    v_cmp_u_f32_e64 vcc, v130, v131
    s_cbranch_vccnz Lhs_5
Lhs_5_ret:
    v_cndmask_b32 v130, v130, v131, s[70:71]
    ds_write_b32 v129, v130 offset:2048
    ds_read_b64_tr_b16 a[120:121], v13 offset:2048
    s_waitcnt lgkmcnt(11)
    v_mfma_f32_32x32x16_bf16 v[48:63], v[216:219], v[24:27], v[48:63]
    ds_read_b64_tr_b16 a[122:123], v13 offset:3072
    ds_read_b64_tr_b16 a[124:125], v13 offset:2560
    ds_read_b64_tr_b16 a[126:127], v13 offset:3584
    s_waitcnt lgkmcnt(10)
    v_mfma_f32_32x32x16_bf16 v[48:63], v[220:223], v[28:31], v[48:63]
    s_waitcnt lgkmcnt(4)
    s_barrier
    s_mov_b32 m0, s48
    s_nop 0
    buffer_load_dwordx4 v8, s[56:59], s33 offen offset:0 lds
    v_mfma_f32_32x32x16_bf16 v[48:63], v[224:227], v[36:39], v[48:63]
    ds_read_b64_tr_b16 v[32:33], v5 offset:4096
    ds_read_b64_tr_b16 v[34:35], v5 offset:4608
    ds_read2st64_b32 v[130:131], v138 offset0:8 offset1:9
    v_mfma_f32_32x32x16_bf16 v[48:63], v[228:231], v[40:43], v[48:63]
    ds_read_b64_tr_b16 v[16:17], v5 offset:5120
    ds_read_b64_tr_b16 v[18:19], v5 offset:5632
    ds_read2st64_b32 v[132:133], v138 offset0:10 offset1:11
    buffer_load_dwordx4 v9, s[56:59], s33 offen offset:1024 lds
    v_mfma_f32_32x32x16_bf16 v[48:63], v[232:235], v[44:47], v[48:63]
    ds_read_b64_tr_b16 v[20:21], v5 offset:6144
    ds_read_b64_tr_b16 v[22:23], v5 offset:6656
    v_mfma_f32_32x32x16_bf16 v[48:63], v[236:239], v[134:137], v[48:63]
    ds_read_b64_tr_b16 v[24:25], v5 offset:7168
    ds_read_b64_tr_b16 v[26:27], v5 offset:7680
    buffer_load_dwordx4 v10, s[56:59], s33 offen offset:2048 lds
    s_waitcnt lgkmcnt(8)
    v_mfma_f32_32x32x16_bf16 v[48:63], v[240:243], v[32:35], v[48:63]
    ds_read_b64_tr_b16 v[28:29], v6 offset:4096
    ds_read_b64_tr_b16 v[30:31], v6 offset:4608
    s_waitcnt vmcnt(13)
    ds_read_b64_tr_b16 v[36:37], v139 offset:8192
    ds_read_b64_tr_b16 v[38:39], v139 offset:8704
    s_waitcnt lgkmcnt(9)
    v_mfma_f32_32x32x16_bf16 v[48:63], v[244:247], v[16:19], v[48:63]
    ds_read_b64_tr_b16 v[32:33], v6 offset:5120
    ds_read_b64_tr_b16 v[34:35], v6 offset:5632
    ds_read_b64_tr_b16 v[40:41], v139 offset:9216
    ds_read_b64_tr_b16 v[42:43], v139 offset:9728
    buffer_load_dwordx4 v11, s[56:59], s33 offen offset:3072 lds
    s_waitcnt lgkmcnt(10)
    v_mfma_f32_32x32x16_bf16 v[48:63], v[248:251], v[20:23], v[48:63]
    ds_read_b64_tr_b16 v[16:17], v6 offset:6144
    ds_read_b64_tr_b16 v[18:19], v6 offset:6656
    ds_read_b64_tr_b16 v[44:45], v139 offset:10240
    ds_read_b64_tr_b16 v[46:47], v139 offset:10752
    s_waitcnt lgkmcnt(12)
    v_mfma_f32_32x32x16_bf16 v[48:63], v[252:255], v[24:27], v[48:63]
    ds_read_b64_tr_b16 v[20:21], v6 offset:7168
    ds_read_b64_tr_b16 v[22:23], v6 offset:7680
    ds_read_b64_tr_b16 v[134:135], v139 offset:11264
    ds_read_b64_tr_b16 v[136:137], v139 offset:11776
    s_mov_b32 m0, s38
    s_nop 0
    buffer_load_dwordx4 v8, s[56:59], s34 offen offset:0 lds
    s_waitcnt lgkmcnt(14)
    v_mfma_f32_32x32x16_bf16 v[48:63], a[224:227], v[28:31], v[48:63]
    ds_read_b64_tr_b16 v[24:25], v7 offset:4096
    ds_read_b64_tr_b16 v[26:27], v7 offset:4608
    s_waitcnt lgkmcnt(14)
    v_mfma_f32_16x16x32_bf16 v[156:159], v[144:147], v[36:39], 0
    s_waitcnt lgkmcnt(12)
    v_mfma_f32_32x32x16_bf16 v[48:63], a[228:231], v[32:35], v[48:63]
    ds_read_b64_tr_b16 v[28:29], v7 offset:5120
    ds_read_b64_tr_b16 v[30:31], v7 offset:5632
    buffer_load_dwordx4 v9, s[56:59], s34 offen offset:1024 lds
    s_waitcnt lgkmcnt(12)
    v_mfma_f32_16x16x32_bf16 v[156:159], v[144:147], v[40:43], v[156:159]
    s_waitcnt lgkmcnt(10)
    v_mfma_f32_32x32x16_bf16 v[48:63], a[232:235], v[16:19], v[48:63]
    ds_read_b64_tr_b16 v[32:33], v7 offset:6144
    ds_read_b64_tr_b16 v[34:35], v7 offset:6656
    s_waitcnt lgkmcnt(10)
    v_mfma_f32_16x16x32_bf16 v[156:159], v[144:147], v[44:47], v[156:159]
    buffer_load_dwordx4 v10, s[56:59], s34 offen offset:2048 lds
    s_waitcnt lgkmcnt(8)
    v_mfma_f32_32x32x16_bf16 v[48:63], a[236:239], v[20:23], v[48:63]
    ds_read_b64_tr_b16 v[16:17], v7 offset:7168
    ds_read_b64_tr_b16 v[18:19], v7 offset:7680
    s_waitcnt lgkmcnt(8)
    v_mfma_f32_16x16x32_bf16 v[156:159], v[144:147], v[134:137], v[156:159]
    s_waitcnt lgkmcnt(6)
    v_mfma_f32_32x32x16_bf16 v[48:63], a[240:243], v[24:27], v[48:63]
    v_add_f32 v130, v130, v131
    v_add_f32 v132, v132, v133
    v_add_f32_e64 v130, v130, v132
    v_mul_f32 v130, 0xbb000000, v130
    buffer_load_dwordx4 v11, s[56:59], s34 offen offset:3072 lds
    s_waitcnt lgkmcnt(4)
    v_mfma_f32_32x32x16_bf16 v[48:63], a[244:247], v[28:31], v[48:63]
    v_cmp_u_f32_e64 vcc, v156, v157
    s_cbranch_vccnz Lhs_6
Lhs_6_ret:
    v_cvt_pk_bf16_f32 v152, v130, v130
    v_cvt_pk_bf16_f32 v153, v130, v130
    s_waitcnt lgkmcnt(2)
    v_mfma_f32_32x32x16_bf16 v[48:63], a[248:251], v[32:35], v[48:63]
    v_mfma_f32_32x32x16_bf16 v[48:63], v[148:151], v[152:155], v[48:63]
    buffer_load_dwordx4 v[80:83], v1, s[44:47], s72 offen offset:0 sc1
    s_waitcnt lgkmcnt(0)
    v_mfma_f32_32x32x16_bf16 v[48:63], a[252:255], v[16:19], v[48:63]
    s_barrier
    v_mfma_f32_32x32x16_bf16 v[64:79], v[160:163], v[36:39], 0
    ds_read_b64_tr_b16 v[20:21], v5 offset:8192
    ds_read_b64_tr_b16 v[22:23], v5 offset:8704
    buffer_load_dwordx4 v[84:87], v1, s[44:47], s72 offen offset:1024 sc1
    v_mfma_f32_32x32x16_bf16 v[64:79], v[164:167], v[40:43], v[64:79]
    ds_read_b64_tr_b16 v[24:25], v5 offset:9216
    ds_read_b64_tr_b16 v[26:27], v5 offset:9728
    s_nop 3
    v_cvt_pk_bf16_f32 v48, v48, v49
    v_pk_max_i16 v48, v48, 0
    v_or_b32_e64 v48, v48, v142
    buffer_load_dwordx4 v[88:91], v1, s[44:47], s73 offen offset:0 sc1
    v_mfma_f32_32x32x16_bf16 v[64:79], v[168:171], v[44:47], v[64:79]
    ds_read_b64_tr_b16 v[28:29], v5 offset:10240
    ds_read_b64_tr_b16 v[30:31], v5 offset:10752
    v_cvt_pk_bf16_f32 v49, v50, v51
    v_pk_max_i16 v49, v49, 0
    v_or_b32_e64 v49, v49, v142
    v_cvt_pk_bf16_f32 v50, v52, v53
    v_mfma_f32_32x32x16_bf16 v[64:79], v[172:175], v[134:137], v[64:79]
    ds_read_b64_tr_b16 v[32:33], v5 offset:11264
    ds_read_b64_tr_b16 v[34:35], v5 offset:11776
    v_pk_max_i16 v50, v50, 0
    v_or_b32_e64 v50, v50, v142
    v_cvt_pk_bf16_f32 v51, v54, v55
    v_pk_max_i16 v51, v51, 0
    buffer_load_dwordx4 v[92:95], v1, s[44:47], s73 offen offset:1024 sc1
    s_waitcnt vmcnt(12)
    ds_read_b64_tr_b16 a[128:129], v13 offset:4096
    s_waitcnt lgkmcnt(7)
    v_mfma_f32_32x32x16_bf16 v[64:79], v[176:179], v[20:23], v[64:79]
    ds_read_b64_tr_b16 v[16:17], v6 offset:8192
    ds_read_b64_tr_b16 v[18:19], v6 offset:8704
    ds_read_b64_tr_b16 v[36:37], v139 offset:12288
    ds_read_b64_tr_b16 v[38:39], v139 offset:12800
    v_or_b32_e64 v51, v51, v142
    buffer_store_dwordx4 v[48:51], v141, s[64:67], s86 offen offset:0 sc1
    v_cvt_pk_bf16_f32 v56, v56, v57
    v_pk_max_i16 v56, v56, 0
    s_waitcnt lgkmcnt(9)
    v_mfma_f32_32x32x16_bf16 v[64:79], v[180:183], v[24:27], v[64:79]
    ds_read_b64_tr_b16 v[20:21], v6 offset:9216
    ds_read_b64_tr_b16 v[22:23], v6 offset:9728
    ds_read_b64_tr_b16 v[40:41], v139 offset:13312
    ds_read_b64_tr_b16 v[42:43], v139 offset:13824
    v_or_b32 v56, v56, v142
    v_cvt_pk_bf16_f32 v57, v58, v59
    v_pk_max_i16 v57, v57, 0
    v_or_b32_e64 v57, v57, v142
    buffer_load_dwordx4 v[96:99], v1, s[44:47], s74 offen offset:0 sc1
    s_waitcnt lgkmcnt(11)
    v_mfma_f32_32x32x16_bf16 v[64:79], v[184:187], v[28:31], v[64:79]
    ds_read_b64_tr_b16 v[24:25], v6 offset:10240
    ds_read_b64_tr_b16 v[26:27], v6 offset:10752
    ds_read_b64_tr_b16 v[44:45], v139 offset:14336
    ds_read_b64_tr_b16 v[46:47], v139 offset:14848
    v_cvt_pk_bf16_f32 v58, v60, v61
    v_pk_max_i16 v58, v58, 0
    v_or_b32 v58, v58, v142
    v_cvt_pk_bf16_f32 v59, v62, v63
    s_waitcnt lgkmcnt(13)
    v_mfma_f32_32x32x16_bf16 v[64:79], v[188:191], v[32:35], v[64:79]
    ds_read_b64_tr_b16 v[28:29], v6 offset:11264
    ds_read_b64_tr_b16 v[30:31], v6 offset:11776
    ds_read_b64_tr_b16 v[134:135], v139 offset:15360
    ds_read_b64_tr_b16 v[136:137], v139 offset:15872
    v_pk_max_i16 v59, v59, 0
    v_or_b32 v59, v59, v142
    buffer_store_dwordx4 v[56:59], v141, s[64:67], s86 offen offset:1024 sc1
    s_waitcnt lgkmcnt(14)
    v_mfma_f32_32x32x16_bf16 v[64:79], v[192:195], v[16:19], v[64:79]
    ds_read_b64_tr_b16 v[32:33], v7 offset:8192
    ds_read_b64_tr_b16 v[34:35], v7 offset:8704
    ds_read_b64_tr_b16 a[130:131], v13 offset:5120
    s_waitcnt lgkmcnt(15)
    v_mfma_f32_16x16x32_bf16 v[130:133], v[144:147], v[36:39], v[156:159]
    ds_read_b64_tr_b16 a[132:133], v13 offset:4608
    s_waitcnt lgkmcnt(14)
    v_mfma_f32_32x32x16_bf16 v[64:79], v[196:199], v[20:23], v[64:79]
    ds_read_b64_tr_b16 v[16:17], v7 offset:9216
    ds_read_b64_tr_b16 v[18:19], v7 offset:9728
    buffer_load_dwordx4 v[100:103], v1, s[44:47], s74 offen offset:1024 sc1
    ds_read_b64_tr_b16 a[134:135], v13 offset:5632
    s_waitcnt lgkmcnt(15)
    v_mfma_f32_16x16x32_bf16 v[130:133], v[144:147], v[40:43], v[130:133]
    ds_read_b64_tr_b16 a[136:137], v13 offset:6144
    s_waitcnt lgkmcnt(14)
    v_mfma_f32_32x32x16_bf16 v[64:79], v[200:203], v[24:27], v[64:79]
    ds_read_b64_tr_b16 v[20:21], v7 offset:10240
    ds_read_b64_tr_b16 v[22:23], v7 offset:10752
    ds_read_b64_tr_b16 a[138:139], v13 offset:7168
    buffer_load_dwordx4 v[104:107], v1, s[44:47], s75 offen offset:0 sc1
    s_waitcnt lgkmcnt(15)
    v_mfma_f32_16x16x32_bf16 v[130:133], v[144:147], v[44:47], v[130:133]
    ds_read_b64_tr_b16 a[140:141], v13 offset:6656
    s_waitcnt lgkmcnt(14)
    v_mfma_f32_32x32x16_bf16 v[64:79], v[204:207], v[28:31], v[64:79]
    ds_read_b64_tr_b16 v[24:25], v7 offset:11264
    ds_read_b64_tr_b16 v[26:27], v7 offset:11776
    ds_read_b64_tr_b16 a[142:143], v13 offset:7680
    s_waitcnt lgkmcnt(15)
    v_mfma_f32_16x16x32_bf16 v[130:133], v[144:147], v[134:137], v[130:133]
    buffer_load_dwordx4 v[108:111], v1, s[44:47], s75 offen offset:1024 sc1
    s_waitcnt vmcnt(14)
    ds_read_b64_tr_b16 a[144:145], v140 offset:0
    s_waitcnt lgkmcnt(14)
    v_mfma_f32_32x32x16_bf16 v[64:79], v[208:211], v[32:35], v[64:79]
    ds_read_b64_tr_b16 a[146:147], v140 offset:1024
    ds_read_b64_tr_b16 a[148:149], v140 offset:512
    ds_read_b64_tr_b16 a[150:151], v140 offset:1536
    s_waitcnt lgkmcnt(13)
    v_mfma_f32_32x32x16_bf16 v[64:79], v[212:215], v[16:19], v[64:79]
    v_cmp_u_f32_e64 vcc, v130, v131
    s_cbranch_vccnz Lhs_7
Lhs_7_ret:
    v_cndmask_b32 v130, v130, v131, s[70:71]
    ds_write_b32 v129, v130 offset:3072
    buffer_load_dwordx4 v[112:115], v1, s[44:47], s76 offen offset:0 sc1
    ds_read_b64_tr_b16 a[152:153], v140 offset:2048
    s_waitcnt lgkmcnt(11)
    v_mfma_f32_32x32x16_bf16 v[64:79], v[216:219], v[20:23], v[64:79]
    ds_read_b64_tr_b16 a[154:155], v140 offset:3072
    ds_read_b64_tr_b16 a[156:157], v140 offset:2560
    ds_read_b64_tr_b16 a[158:159], v140 offset:3584
    s_waitcnt lgkmcnt(10)
    v_mfma_f32_32x32x16_bf16 v[64:79], v[220:223], v[24:27], v[64:79]
    s_waitcnt lgkmcnt(4)
    s_barrier
    buffer_load_dwordx4 v[116:119], v1, s[44:47], s76 offen offset:1024 sc1
    s_waitcnt vmcnt(12)
    ds_read_b64_tr_b16 a[160:161], v13 offset:0
    v_mfma_f32_32x32x16_bf16 v[64:79], v[224:227], v[36:39], v[64:79]
    ds_read_b64_tr_b16 v[28:29], v5 offset:12288
    ds_read_b64_tr_b16 v[30:31], v5 offset:12800
    ds_read2st64_b32 v[130:131], v138 offset0:12 offset1:13
    v_mfma_f32_32x32x16_bf16 v[64:79], v[228:231], v[40:43], v[64:79]
    ds_read_b64_tr_b16 v[32:33], v5 offset:13312
    ds_read_b64_tr_b16 v[34:35], v5 offset:13824
    ds_read2st64_b32 v[132:133], v138 offset0:14 offset1:15
    buffer_load_dwordx4 v[120:123], v1, s[44:47], s77 offen offset:0 sc1
    v_mfma_f32_32x32x16_bf16 v[64:79], v[232:235], v[44:47], v[64:79]
    ds_read_b64_tr_b16 v[16:17], v5 offset:14336
    ds_read_b64_tr_b16 v[18:19], v5 offset:14848
    ds_read_b64_tr_b16 a[162:163], v13 offset:1024
    v_mfma_f32_32x32x16_bf16 v[64:79], v[236:239], v[134:137], v[64:79]
    ds_read_b64_tr_b16 v[20:21], v5 offset:15360
    ds_read_b64_tr_b16 v[22:23], v5 offset:15872
    buffer_load_dwordx4 v[124:127], v1, s[44:47], s77 offen offset:1024 sc1
    ds_read_b64_tr_b16 a[164:165], v13 offset:512
    s_waitcnt lgkmcnt(10)
    v_mfma_f32_32x32x16_bf16 v[64:79], v[240:243], v[28:31], v[64:79]
    ds_read_b64_tr_b16 v[24:25], v6 offset:12288
    ds_read_b64_tr_b16 v[26:27], v6 offset:12800
    ds_read_b64_tr_b16 a[166:167], v13 offset:1536
    s_waitcnt lgkmcnt(10)
    v_mfma_f32_32x32x16_bf16 v[64:79], v[244:247], v[32:35], v[64:79]
    ds_read_b64_tr_b16 v[28:29], v6 offset:13312
    ds_read_b64_tr_b16 v[30:31], v6 offset:13824
    s_mov_b32 m0, s48
    s_nop 0
    buffer_load_dwordx4 v8, s[56:59], s35 offen offset:0 lds
    ds_read_b64_tr_b16 a[168:169], v13 offset:2048
    s_waitcnt lgkmcnt(10)
    v_mfma_f32_32x32x16_bf16 v[64:79], v[248:251], v[16:19], v[64:79]
    ds_read_b64_tr_b16 v[32:33], v6 offset:14336
    ds_read_b64_tr_b16 v[34:35], v6 offset:14848
    ds_read_b64_tr_b16 a[170:171], v13 offset:3072
    s_waitcnt lgkmcnt(10)
    v_mfma_f32_32x32x16_bf16 v[64:79], v[252:255], v[20:23], v[64:79]
    ds_read_b64_tr_b16 v[16:17], v6 offset:15360
    ds_read_b64_tr_b16 v[18:19], v6 offset:15872
    buffer_load_dwordx4 v9, s[56:59], s35 offen offset:1024 lds
    ds_read_b64_tr_b16 a[172:173], v13 offset:2560
    s_waitcnt lgkmcnt(10)
    v_mfma_f32_32x32x16_bf16 v[64:79], a[224:227], v[24:27], v[64:79]
    ds_read_b64_tr_b16 v[20:21], v7 offset:12288
    ds_read_b64_tr_b16 v[22:23], v7 offset:12800
    ds_read_b64_tr_b16 a[174:175], v13 offset:3584
    s_waitcnt lgkmcnt(10)
    v_mfma_f32_32x32x16_bf16 v[64:79], a[228:231], v[28:31], v[64:79]
    ds_read_b64_tr_b16 v[24:25], v7 offset:13312
    ds_read_b64_tr_b16 v[26:27], v7 offset:13824
    buffer_load_dwordx4 v10, s[56:59], s35 offen offset:2048 lds
    s_waitcnt lgkmcnt(9)
    v_mfma_f32_32x32x16_bf16 v[64:79], a[232:235], v[32:35], v[64:79]
    ds_read_b64_tr_b16 v[28:29], v7 offset:14336
    ds_read_b64_tr_b16 v[30:31], v7 offset:14848
    s_waitcnt lgkmcnt(8)
    v_mfma_f32_32x32x16_bf16 v[64:79], a[236:239], v[16:19], v[64:79]
    ds_read_b64_tr_b16 v[32:33], v7 offset:15360
    ds_read_b64_tr_b16 v[34:35], v7 offset:15872
    buffer_load_dwordx4 v11, s[56:59], s35 offen offset:3072 lds
    s_waitcnt lgkmcnt(7)
    v_mfma_f32_32x32x16_bf16 v[64:79], a[240:243], v[20:23], v[64:79]
    v_add_f32 v130, v130, v131
    v_add_f32 v132, v132, v133
    v_add_f32_e64 v15, v130, v132
    v_mul_f32 v130, 0xbb000000, v15
    s_waitcnt lgkmcnt(4)
    v_mfma_f32_32x32x16_bf16 v[64:79], a[244:247], v[24:27], v[64:79]
    v_cvt_pk_bf16_f32 v152, v130, v130
    v_cvt_pk_bf16_f32 v153, v130, v130
    buffer_load_dwordx4 v[160:163], v1, s[44:47], s78 offen offset:0 sc1
    s_waitcnt lgkmcnt(2)
    v_mfma_f32_32x32x16_bf16 v[64:79], a[248:251], v[28:31], v[64:79]
    v_mfma_f32_32x32x16_bf16 v[64:79], v[148:151], v[152:155], v[64:79]
    buffer_load_dwordx4 v[164:167], v1, s[44:47], s78 offen offset:1024 sc1
    s_waitcnt lgkmcnt(0)
    v_mfma_f32_32x32x16_bf16 v[64:79], a[252:255], v[32:35], v[64:79]
    s_waitcnt vmcnt(16)
    v_xor_b32_e64 v135, v80, v142
    v_bitop3_b32 v135, v135, v81, v142 bitop3:0xf6
    v_bitop3_b32 v135, v135, v82, v142 bitop3:0xf6
    v_bitop3_b32 v135, v135, v83, v142 bitop3:0xf6
    v_bitop3_b32 v135, v135, v84, v142 bitop3:0xf6
    v_bitop3_b32 v135, v135, v85, v142 bitop3:0xf6
    v_bitop3_b32 v135, v135, v86, v142 bitop3:0xf6
    v_bitop3_b32 v135, v135, v87, v142 bitop3:0xf6
    v_bitop3_b32 v135, v135, v88, v142 bitop3:0xf6
    v_bitop3_b32 v135, v135, v89, v142 bitop3:0xf6
    v_bitop3_b32 v135, v135, v90, v142 bitop3:0xf6
    v_bitop3_b32 v135, v135, v91, v142 bitop3:0xf6
    v_bitop3_b32 v135, v135, v92, v142 bitop3:0xf6
    v_bitop3_b32 v135, v135, v93, v142 bitop3:0xf6
    v_bitop3_b32 v135, v135, v94, v142 bitop3:0xf6
    v_bitop3_b32 v135, v135, v95, v142 bitop3:0xf6
    v_and_b32 v135, s96, v135
    v_cmp_ne_u32_e64 vcc, 0, v135
    s_cbranch_vccnz Lfs_0
Lfs_0_ret:
    v_mfma_f32_32x32x16_bf16 v[16:31], a[0:3], v[80:83], 0
    v_cvt_pk_bf16_f32 v64, v64, v65
    v_pk_max_i16 v64, v64, 0
    buffer_load_dwordx4 v[168:171], v1, s[44:47], s79 offen offset:0 sc1
    v_or_b32_e64 v64, v64, v142
    v_cvt_pk_bf16_f32 v65, v66, v67
    v_mfma_f32_32x32x16_bf16 v[32:47], a[4:7], v[80:83], 0
    s_waitcnt vmcnt(11)
    v_xor_b32 v135, v96, v142
    v_bitop3_b32 v135, v135, v97, v142 bitop3:0xf6
    v_bitop3_b32 v135, v135, v98, v142 bitop3:0xf6
    v_pk_max_i16 v65, v65, 0
    v_or_b32_e64 v65, v65, v142
    v_cvt_pk_bf16_f32 v66, v68, v69
    buffer_load_dwordx4 v[172:175], v1, s[44:47], s79 offen offset:1024 sc1
    v_mfma_f32_32x32x16_bf16 v[16:31], a[8:11], v[84:87], v[16:31]
    v_bitop3_b32 v135, v135, v99, v142 bitop3:0xf6
    v_bitop3_b32 v135, v135, v100, v142 bitop3:0xf6
    v_bitop3_b32 v135, v135, v101, v142 bitop3:0xf6
    v_pk_max_i16 v66, v66, 0
    v_or_b32_e64 v66, v66, v142
    v_cvt_pk_bf16_f32 v67, v70, v71
    v_mfma_f32_32x32x16_bf16 v[32:47], a[12:15], v[84:87], v[32:47]
    v_bitop3_b32 v135, v135, v102, v142 bitop3:0xf6
    v_bitop3_b32 v135, v135, v103, v142 bitop3:0xf6
    v_bitop3_b32 v135, v135, v104, v142 bitop3:0xf6
    v_pk_max_i16 v67, v67, 0
    v_or_b32_e64 v67, v67, v142
    buffer_store_dwordx4 v[64:67], v141, s[64:67], s87 offen offset:0 sc1
    v_mfma_f32_32x32x16_bf16 v[16:31], a[16:19], v[88:91], v[16:31]
    v_bitop3_b32 v135, v135, v105, v142 bitop3:0xf6
    v_bitop3_b32 v135, v135, v106, v142 bitop3:0xf6
    v_bitop3_b32 v135, v135, v107, v142 bitop3:0xf6
    v_cvt_pk_bf16_f32 v72, v72, v73
    v_pk_max_i16 v72, v72, 0
    v_or_b32_e64 v72, v72, v142
    v_mfma_f32_32x32x16_bf16 v[32:47], a[20:23], v[88:91], v[32:47]
    v_bitop3_b32 v135, v135, v108, v142 bitop3:0xf6
    v_bitop3_b32 v135, v135, v109, v142 bitop3:0xf6
    v_bitop3_b32 v135, v135, v110, v142 bitop3:0xf6
    v_cvt_pk_bf16_f32 v73, v74, v75
    v_pk_max_i16 v73, v73, 0
    v_or_b32_e64 v73, v73, v142
    buffer_load_dwordx4 v[176:179], v1, s[44:47], s80 offen offset:0 sc1
    v_mfma_f32_32x32x16_bf16 v[16:31], a[24:27], v[92:95], v[16:31]
    v_bitop3_b32 v135, v135, v111, v142 bitop3:0xf6
    v_and_b32 v135, s96, v135
    v_cmp_ne_u32 vcc, 0, v135
    v_cvt_pk_bf16_f32 v74, v76, v77
    v_pk_max_i16 v74, v74, 0
    v_or_b32_e64 v74, v74, v142
    v_mfma_f32_32x32x16_bf16 v[32:47], a[28:31], v[92:95], v[32:47]
    s_cbranch_vccnz Lfs_1
Lfs_1_ret:
    v_cvt_pk_bf16_f32 v75, v78, v79
    v_pk_max_i16 v75, v75, 0
    v_or_b32 v75, v75, v142
    buffer_load_dwordx4 v[180:183], v1, s[44:47], s80 offen offset:1024 sc1
    v_mfma_f32_32x32x16_bf16 v[16:31], a[32:35], v[96:99], v[16:31]
    buffer_store_dwordx4 v[72:75], v141, s[64:67], s87 offen offset:1024 sc1
    v_add_u32 v4, 49152, v128
    v_and_b32 v4, 0xffff, v4
    v_xor_b32 v5, 32768, v128
    v_add_u32 v6, 16384, v128
    v_mfma_f32_32x32x16_bf16 v[32:47], a[36:39], v[96:99], v[32:47]
    s_waitcnt vmcnt(12)
    v_xor_b32 v135, v112, v142
    v_bitop3_b32 v135, v135, v113, v142 bitop3:0xf6
    v_bitop3_b32 v135, v135, v114, v142 bitop3:0xf6
    buffer_load_dwordx4 v[184:187], v1, s[44:47], s81 offen offset:0 sc1
    v_mfma_f32_32x32x16_bf16 v[16:31], a[40:43], v[100:103], v[16:31]
    v_bitop3_b32 v135, v135, v115, v142 bitop3:0xf6
    v_bitop3_b32 v135, v135, v116, v142 bitop3:0xf6
    v_bitop3_b32 v135, v135, v117, v142 bitop3:0xf6
    v_and_b32 v6, 0xffff, v6
    v_add_u32_e64 v7, s89, v3
    v_mfma_f32_32x32x16_bf16 v[32:47], a[44:47], v[100:103], v[32:47]
    v_bitop3_b32 v135, v135, v118, v142 bitop3:0xf6
    v_bitop3_b32 v135, v135, v119, v142 bitop3:0xf6
    v_bitop3_b32 v135, v135, v120, v142 bitop3:0xf6
    buffer_load_dwordx4 v[188:191], v1, s[44:47], s81 offen offset:1024 sc1
    v_and_b32_e64 v138, 31, v12
    v_mfma_f32_32x32x16_bf16 v[16:31], a[48:51], v[104:107], v[16:31]
    v_bitop3_b32 v135, v135, v121, v142 bitop3:0xf6
    v_bitop3_b32 v135, v135, v122, v142 bitop3:0xf6
    v_bitop3_b32 v135, v135, v123, v142 bitop3:0xf6
    v_lshlrev_b32 v2, 10, v138
    v_lshrrev_b32 v129, 5, v12
    v_mfma_f32_32x32x16_bf16 v[32:47], a[52:55], v[104:107], v[32:47]
    v_bitop3_b32 v135, v135, v124, v142 bitop3:0xf6
    v_bitop3_b32 v135, v135, v125, v142 bitop3:0xf6
    v_bitop3_b32 v135, v135, v126, v142 bitop3:0xf6
    buffer_load_dwordx4 v[192:195], v1, s[44:47], s82 offen offset:0 sc1
    v_lshl_add_u32 v2, v129, 4, v2
    v_mfma_f32_32x32x16_bf16 v[16:31], a[56:59], v[108:111], v[16:31]
    v_bitop3_b32 v135, v135, v127, v142 bitop3:0xf6
    v_and_b32 v135, s96, v135
    v_cmp_ne_u32 vcc, 0, v135
    v_lshlrev_b32_e64 v138, 5, v138
    v_add_u32 v138, 155648, v138
    v_mfma_f32_32x32x16_bf16 v[32:47], a[60:63], v[108:111], v[32:47]
    s_cbranch_vccnz Lfs_2
Lfs_2_ret:
    buffer_load_dwordx4 v[196:199], v1, s[44:47], s82 offen offset:1024 sc1
    s_waitcnt vmcnt(12)
    ds_read_b64_tr_b16 a[176:177], v140 offset:0
    v_lshrrev_b32_e64 v129, 5, v0
    v_mfma_f32_32x32x16_bf16 v[16:31], a[64:67], v[112:115], v[16:31]
    ds_read_b64_tr_b16 a[178:179], v140 offset:1024
    v_lshl_add_u32 v129, v129, 2, v138
    s_add_u32 s89, s88, 0x100000
    ds_read_b64_tr_b16 v[48:49], v13 offset:8192
    buffer_load_dwordx4 v[200:203], v1, s[44:47], s83 offen offset:0 sc1
    v_mfma_f32_32x32x16_bf16 v[32:47], a[68:71], v[112:115], v[32:47]
    s_waitcnt vmcnt(9)
    v_xor_b32 v135, v160, v142
    v_bitop3_b32 v135, v135, v161, v142 bitop3:0xf6
    v_bitop3_b32 v135, v135, v162, v142 bitop3:0xf6
    ds_read_b64_tr_b16 a[180:181], v140 offset:512
    v_mfma_f32_32x32x16_bf16 v[16:31], a[72:75], v[116:119], v[16:31]
    v_bitop3_b32 v135, v135, v163, v142 bitop3:0xf6
    v_bitop3_b32 v135, v135, v164, v142 bitop3:0xf6
    v_bitop3_b32 v135, v135, v165, v142 bitop3:0xf6
    buffer_load_dwordx4 v[204:207], v1, s[44:47], s83 offen offset:1024 sc1
    ds_read_b64_tr_b16 a[182:183], v140 offset:1536
    v_mfma_f32_32x32x16_bf16 v[32:47], a[76:79], v[116:119], v[32:47]
    v_bitop3_b32 v135, v135, v166, v142 bitop3:0xf6
    v_bitop3_b32 v135, v135, v167, v142 bitop3:0xf6
    v_bitop3_b32 v135, v135, v168, v142 bitop3:0xf6
    ds_read_b64_tr_b16 a[184:185], v140 offset:2048
    ds_read_b64_tr_b16 v[50:51], v13 offset:8704
    v_mfma_f32_32x32x16_bf16 v[16:31], a[80:83], v[120:123], v[16:31]
    v_bitop3_b32 v135, v135, v169, v142 bitop3:0xf6
    v_bitop3_b32 v135, v135, v170, v142 bitop3:0xf6
    v_bitop3_b32 v135, v135, v171, v142 bitop3:0xf6
    s_mov_b32 m0, s38
    s_nop 0
    buffer_load_dwordx4 v8, s[56:59], s36 offen offset:0 lds
    ds_read_b64_tr_b16 a[186:187], v140 offset:3072
    v_mfma_f32_32x32x16_bf16 v[32:47], a[84:87], v[120:123], v[32:47]
    v_bitop3_b32 v135, v135, v172, v142 bitop3:0xf6
    v_bitop3_b32 v135, v135, v173, v142 bitop3:0xf6
    v_bitop3_b32 v135, v135, v174, v142 bitop3:0xf6
    ds_read_b64_tr_b16 a[188:189], v140 offset:2560
    ds_read_b64_tr_b16 v[52:53], v13 offset:9216
    v_mfma_f32_32x32x16_bf16 v[16:31], a[88:91], v[124:127], v[16:31]
    v_bitop3_b32 v135, v135, v175, v142 bitop3:0xf6
    v_and_b32 v135, s96, v135
    v_cmp_ne_u32 vcc, 0, v135
    buffer_load_dwordx4 v9, s[56:59], s36 offen offset:1024 lds
    ds_read_b64_tr_b16 a[190:191], v140 offset:3584
    v_mfma_f32_32x32x16_bf16 v[32:47], a[92:95], v[124:127], v[32:47]
    s_cbranch_vccnz Lfs_3
Lfs_3_ret:
    ds_read_b64_tr_b16 v[54:55], v13 offset:9728
    ds_read_b64_tr_b16 v[56:57], v13 offset:10240
    ds_read_b64_tr_b16 v[58:59], v13 offset:10752
    ds_read_b64_tr_b16 v[60:61], v13 offset:11264
    ds_read_b64_tr_b16 v[62:63], v13 offset:11776
    buffer_load_dwordx4 v10, s[56:59], s36 offen offset:2048 lds
    ds_read_b64_tr_b16 v[64:65], v13 offset:12288
    ds_read_b64_tr_b16 v[66:67], v13 offset:12800
    ds_read_b64_tr_b16 v[68:69], v13 offset:13312
    ds_read_b64_tr_b16 v[70:71], v13 offset:13824
    ds_read_b64_tr_b16 v[72:73], v13 offset:14336
    ds_read_b64_tr_b16 v[74:75], v13 offset:14848
    ds_read_b64_tr_b16 v[76:77], v13 offset:15360
    ds_read_b64_tr_b16 v[78:79], v13 offset:15872
    s_waitcnt lgkmcnt(0)
    v_dot2_f32_bf16 v152, v48, v48, 0
    buffer_load_dwordx4 v11, s[56:59], s36 offen offset:3072 lds
    v_dot2_f32_bf16 v153, v49, v49, 0
    v_dot2_f32_bf16 v152, v50, v50, v152
    v_dot2_f32_bf16 v153, v51, v51, v153
    v_dot2_f32_bf16 v152, v52, v52, v152
    v_dot2_f32_bf16 v153, v53, v53, v153
    v_dot2_f32_bf16 v152, v54, v54, v152
    v_dot2_f32_bf16 v153, v55, v55, v153
    v_dot2_f32_bf16 v152, v56, v56, v152
    v_dot2_f32_bf16 v153, v57, v57, v153
    v_dot2_f32_bf16 v152, v58, v58, v152
    s_mov_b32 m0, s39
    s_nop 0
    buffer_load_dwordx4 v8, s[56:59], s37 offen offset:0 lds
    v_dot2_f32_bf16 v153, v59, v59, v153
    v_dot2_f32_bf16 v152, v60, v60, v152
    v_dot2_f32_bf16 v153, v61, v61, v153
    v_dot2_f32_bf16 v152, v62, v62, v152
    v_dot2_f32_bf16 v153, v63, v63, v153
    v_dot2_f32_bf16 v152, v64, v64, v152
    v_dot2_f32_bf16 v153, v65, v65, v153
    v_dot2_f32_bf16 v152, v66, v66, v152
    v_dot2_f32_bf16 v153, v67, v67, v153
    v_dot2_f32_bf16 v152, v68, v68, v152
    buffer_load_dwordx4 v9, s[56:59], s37 offen offset:1024 lds
    v_dot2_f32_bf16 v153, v69, v69, v153
    v_dot2_f32_bf16 v152, v70, v70, v152
    v_dot2_f32_bf16 v153, v71, v71, v153
    v_dot2_f32_bf16 v152, v72, v72, v152
    v_dot2_f32_bf16 v153, v73, v73, v153
    v_dot2_f32_bf16 v152, v74, v74, v152
    v_dot2_f32_bf16 v153, v75, v75, v153
    v_dot2_f32_bf16 v152, v76, v76, v152
    v_dot2_f32_bf16 v153, v77, v77, v153
    v_dot2_f32_bf16 v152, v78, v78, v152
    buffer_load_dwordx4 v10, s[56:59], s37 offen offset:2048 lds
    v_dot2_f32_bf16 v153, v79, v79, v153
    v_mfma_f32_32x32x16_bf16 v[16:31], a[96:99], v[160:163], v[16:31]
    ds_read_b64_tr_b16 v[48:49], v139 offset:8192
    ds_read_b64_tr_b16 v[50:51], v139 offset:8704
    ds_read_b64_tr_b16 v[52:53], v139 offset:9216
    v_mfma_f32_32x32x16_bf16 v[32:47], a[100:103], v[160:163], v[32:47]
    s_waitcnt vmcnt(11)
    v_xor_b32 v135, v176, v142
    v_bitop3_b32 v135, v135, v177, v142 bitop3:0xf6
    v_bitop3_b32 v135, v135, v178, v142 bitop3:0xf6
    buffer_load_dwordx4 v11, s[56:59], s37 offen offset:3072 lds
    v_mfma_f32_32x32x16_bf16 v[16:31], a[104:107], v[164:167], v[16:31]
    v_bitop3_b32 v135, v135, v179, v142 bitop3:0xf6
    v_bitop3_b32 v135, v135, v180, v142 bitop3:0xf6
    v_bitop3_b32 v135, v135, v181, v142 bitop3:0xf6
    ds_read_b64_tr_b16 v[54:55], v139 offset:9728
    ds_read_b64_tr_b16 v[56:57], v139 offset:10240
    v_mfma_f32_32x32x16_bf16 v[32:47], a[108:111], v[164:167], v[32:47]
    v_bitop3_b32 v135, v135, v182, v142 bitop3:0xf6
    v_bitop3_b32 v135, v135, v183, v142 bitop3:0xf6
    v_bitop3_b32 v135, v135, v184, v142 bitop3:0xf6
    buffer_load_dwordx4 v[208:211], v1, s[44:47], s84 offen offset:0 sc1
    ds_read_b64_tr_b16 v[58:59], v139 offset:10752
    v_mfma_f32_32x32x16_bf16 v[16:31], a[112:115], v[168:171], v[16:31]
    v_bitop3_b32 v135, v135, v185, v142 bitop3:0xf6
    v_bitop3_b32 v135, v135, v186, v142 bitop3:0xf6
    v_bitop3_b32 v135, v135, v187, v142 bitop3:0xf6
    ds_read_b64_tr_b16 v[60:61], v139 offset:11264
    ds_read_b64_tr_b16 v[62:63], v139 offset:11776
    v_mfma_f32_32x32x16_bf16 v[32:47], a[116:119], v[168:171], v[32:47]
    v_bitop3_b32 v135, v135, v188, v142 bitop3:0xf6
    v_bitop3_b32 v135, v135, v189, v142 bitop3:0xf6
    v_bitop3_b32 v135, v135, v190, v142 bitop3:0xf6
    buffer_load_dwordx4 v[212:215], v1, s[44:47], s84 offen offset:1024 sc1
    ds_read_b64_tr_b16 v[64:65], v139 offset:12288
    v_mfma_f32_32x32x16_bf16 v[16:31], a[120:123], v[172:175], v[16:31]
    v_bitop3_b32 v135, v135, v191, v142 bitop3:0xf6
    v_and_b32 v135, s96, v135
    v_cmp_ne_u32 vcc, 0, v135
    ds_read_b64_tr_b16 v[66:67], v139 offset:12800
    ds_read_b64_tr_b16 v[68:69], v139 offset:13312
    v_mfma_f32_32x32x16_bf16 v[32:47], a[124:127], v[172:175], v[32:47]
    s_cbranch_vccnz Lfs_4
Lfs_4_ret:
    buffer_load_dwordx4 v[216:219], v1, s[44:47], s85 offen offset:0 sc1
    ds_read_b64_tr_b16 v[70:71], v139 offset:13824
    ds_read_b64_tr_b16 v[72:73], v139 offset:14336
    ds_read_b64_tr_b16 v[74:75], v139 offset:14848
    ds_read_b64_tr_b16 v[76:77], v139 offset:15360
    ds_read_b64_tr_b16 v[78:79], v139 offset:15872
    s_waitcnt lgkmcnt(0)
    v_dot2_f32_bf16 v154, v48, v48, 0
    v_dot2_f32_bf16 v155, v49, v49, 0
    v_dot2_f32_bf16 v154, v50, v50, v154
    v_dot2_f32_bf16 v155, v51, v51, v155
    buffer_load_dwordx4 v[220:223], v1, s[44:47], s85 offen offset:1024 sc1
    v_dot2_f32_bf16 v154, v52, v52, v154
    v_dot2_f32_bf16 v155, v53, v53, v155
    v_dot2_f32_bf16 v154, v54, v54, v154
    v_dot2_f32_bf16 v155, v55, v55, v155
    v_dot2_f32_bf16 v154, v56, v56, v154
    v_dot2_f32_bf16 v155, v57, v57, v155
    v_dot2_f32_bf16 v154, v58, v58, v154
    v_dot2_f32_bf16 v155, v59, v59, v155
    v_dot2_f32_bf16 v154, v60, v60, v154
    v_dot2_f32_bf16 v155, v61, v61, v155
    buffer_load_dwordx4 v[224:227], v141, s[44:47], s72 offen offset:0 sc1
    v_dot2_f32_bf16 v154, v62, v62, v154
    v_dot2_f32_bf16 v155, v63, v63, v155
    v_dot2_f32_bf16 v154, v64, v64, v154
    v_dot2_f32_bf16 v155, v65, v65, v155
    v_dot2_f32_bf16 v154, v66, v66, v154
    v_dot2_f32_bf16 v155, v67, v67, v155
    v_dot2_f32_bf16 v154, v68, v68, v154
    v_dot2_f32_bf16 v155, v69, v69, v155
    v_dot2_f32_bf16 v154, v70, v70, v154
    v_dot2_f32_bf16 v155, v71, v71, v155
    buffer_load_dwordx4 v[228:231], v141, s[44:47], s72 offen offset:1024 sc1
    v_dot2_f32_bf16 v154, v72, v72, v154
    v_dot2_f32_bf16 v155, v73, v73, v155
    v_dot2_f32_bf16 v154, v74, v74, v154
    v_dot2_f32_bf16 v155, v75, v75, v155
    v_dot2_f32_bf16 v154, v76, v76, v154
    v_dot2_f32_bf16 v155, v77, v77, v155
    v_dot2_f32_bf16 v154, v78, v78, v154
    v_dot2_f32_bf16 v155, v79, v79, v155
    v_mfma_f32_32x32x16_bf16 v[16:31], a[128:131], v[176:179], v[16:31]
    buffer_load_dwordx4 v[232:235], v141, s[44:47], s73 offen offset:0 sc1
    s_nop 1
    v_add_f32 v152, v152, v153
    v_add_f32_e64 v154, v154, v155
    v_mfma_f32_32x32x16_bf16 v[32:47], a[132:135], v[176:179], v[32:47]
    s_waitcnt vmcnt(15)
    v_xor_b32 v135, v192, v142
    v_bitop3_b32 v135, v135, v193, v142 bitop3:0xf6
    v_bitop3_b32 v135, v135, v194, v142 bitop3:0xf6
    buffer_load_dwordx4 v[236:239], v141, s[44:47], s73 offen offset:1024 sc1
    s_waitcnt vmcnt(12)
    ds_read_b64_tr_b16 a[192:193], v13 offset:0
    v_mfma_f32_32x32x16_bf16 v[16:31], a[136:139], v[180:183], v[16:31]
    v_bitop3_b32 v135, v135, v195, v142 bitop3:0xf6
    v_bitop3_b32 v135, v135, v196, v142 bitop3:0xf6
    v_bitop3_b32 v135, v135, v197, v142 bitop3:0xf6
    ds_read_b64_tr_b16 a[194:195], v13 offset:1024
    ds_write2st64_b32 v129, v152, v154 offset0:0 offset1:4
    v_mfma_f32_32x32x16_bf16 v[32:47], a[140:143], v[180:183], v[32:47]
    v_bitop3_b32 v135, v135, v198, v142 bitop3:0xf6
    v_bitop3_b32 v135, v135, v199, v142 bitop3:0xf6
    v_bitop3_b32 v135, v135, v200, v142 bitop3:0xf6
    buffer_load_dwordx4 v[240:243], v141, s[44:47], s74 offen offset:0 sc1
    ds_read_b64_tr_b16 a[196:197], v13 offset:512
    v_mfma_f32_32x32x16_bf16 v[16:31], a[144:147], v[184:187], v[16:31]
    v_bitop3_b32 v135, v135, v201, v142 bitop3:0xf6
    v_bitop3_b32 v135, v135, v202, v142 bitop3:0xf6
    v_bitop3_b32 v135, v135, v203, v142 bitop3:0xf6
    ds_read_b64_tr_b16 a[198:199], v13 offset:1536
    ds_read_b64_tr_b16 a[200:201], v13 offset:2048
    v_mfma_f32_32x32x16_bf16 v[32:47], a[148:151], v[184:187], v[32:47]
    v_bitop3_b32 v135, v135, v204, v142 bitop3:0xf6
    v_bitop3_b32 v135, v135, v205, v142 bitop3:0xf6
    v_bitop3_b32 v135, v135, v206, v142 bitop3:0xf6
    buffer_load_dwordx4 v[244:247], v141, s[44:47], s74 offen offset:1024 sc1
    ds_read_b64_tr_b16 a[202:203], v13 offset:3072
    v_mfma_f32_32x32x16_bf16 v[16:31], a[152:155], v[188:191], v[16:31]
    v_bitop3_b32 v135, v135, v207, v142 bitop3:0xf6
    v_and_b32 v135, s96, v135
    v_cmp_ne_u32_e64 vcc, 0, v135
    ds_read_b64_tr_b16 a[204:205], v13 offset:2560
    ds_read_b64_tr_b16 a[206:207], v13 offset:3584
    v_mfma_f32_32x32x16_bf16 v[32:47], a[156:159], v[188:191], v[32:47]
    s_cbranch_vccnz Lfs_5
Lfs_5_ret:
    buffer_load_dwordx4 v[248:251], v141, s[44:47], s75 offen offset:0 sc1
    v_mfma_f32_32x32x16_bf16 v[16:31], a[160:163], v[192:195], v[16:31]
    s_waitcnt lgkmcnt(6)
    s_barrier
    ds_read_b128 v[80:83], v138
    buffer_load_dwordx4 v[252:255], v141, s[44:47], s75 offen offset:1024 sc1
    v_mfma_f32_32x32x16_bf16 v[32:47], a[164:167], v[192:195], v[32:47]
    s_waitcnt vmcnt(8)
    v_xor_b32_e64 v135, v208, v142
    v_bitop3_b32 v135, v135, v209, v142 bitop3:0xf6
    v_bitop3_b32 v135, v135, v210, v142 bitop3:0xf6
    ds_read_b64_tr_b16 a[208:209], v13 offset:4096
    v_mfma_f32_32x32x16_bf16 v[16:31], a[168:171], v[196:199], v[16:31]
    v_bitop3_b32 v135, v135, v211, v142 bitop3:0xf6
    v_bitop3_b32 v135, v135, v212, v142 bitop3:0xf6
    v_bitop3_b32 v135, v135, v213, v142 bitop3:0xf6
    buffer_load_dwordx4 v[160:163], v141, s[44:47], s76 offen offset:0 sc1
    ds_read_b64_tr_b16 a[210:211], v13 offset:5120
    v_mfma_f32_32x32x16_bf16 v[32:47], a[172:175], v[196:199], v[32:47]
    v_bitop3_b32 v135, v135, v214, v142 bitop3:0xf6
    v_bitop3_b32 v135, v135, v215, v142 bitop3:0xf6
    v_bitop3_b32 v135, v135, v216, v142 bitop3:0xf6
    ds_read_b64_tr_b16 a[212:213], v13 offset:4608
    ds_read_b128 v[84:87], v138 offset:16
    v_mfma_f32_32x32x16_bf16 v[16:31], a[176:179], v[200:203], v[16:31]
    v_bitop3_b32 v135, v135, v217, v142 bitop3:0xf6
    v_bitop3_b32 v135, v135, v218, v142 bitop3:0xf6
    v_bitop3_b32 v135, v135, v219, v142 bitop3:0xf6
    buffer_load_dwordx4 v[164:167], v141, s[44:47], s76 offen offset:1024 sc1
    ds_read_b64_tr_b16 a[214:215], v13 offset:5632
    v_mfma_f32_32x32x16_bf16 v[32:47], a[180:183], v[200:203], v[32:47]
    v_bitop3_b32 v135, v135, v220, v142 bitop3:0xf6
    v_bitop3_b32 v135, v135, v221, v142 bitop3:0xf6
    v_bitop3_b32 v135, v135, v222, v142 bitop3:0xf6
    ds_read_b64_tr_b16 a[216:217], v13 offset:6144
    ds_read_b128 v[88:91], v138 offset:1024
    v_mfma_f32_32x32x16_bf16 v[16:31], a[184:187], v[204:207], v[16:31]
    v_bitop3_b32 v135, v135, v223, v142 bitop3:0xf6
    v_and_b32 v135, s96, v135
    v_cmp_ne_u32 vcc, 0, v135
    buffer_load_dwordx4 v[168:171], v141, s[44:47], s77 offen offset:0 sc1
    ds_read_b64_tr_b16 a[218:219], v13 offset:7168
    v_mfma_f32_32x32x16_bf16 v[32:47], a[188:191], v[204:207], v[32:47]
    s_cbranch_vccnz Lfs_6
Lfs_6_ret:
    ds_read_b64_tr_b16 a[220:221], v13 offset:6656
    ds_read_b128 v[92:95], v138 offset:1040
    ds_read_b64_tr_b16 a[222:223], v13 offset:7680
    s_waitcnt lgkmcnt(12)
    s_waitcnt lgkmcnt(0)
    v_mfma_f32_32x32x16_bf16 v[16:31], a[192:195], v[208:211], v[16:31]
    buffer_load_dwordx4 v[172:175], v141, s[44:47], s77 offen offset:1024 sc1
    v_mfma_f32_32x32x16_bf16 v[32:47], a[196:199], v[208:211], v[32:47]
    s_waitcnt vmcnt(8)
    v_xor_b32_e64 v135, v224, v142
    v_bitop3_b32 v135, v135, v225, v142 bitop3:0xf6
    v_bitop3_b32 v135, v135, v226, v142 bitop3:0xf6
    buffer_load_dwordx4 v[176:179], v141, s[44:47], s78 offen offset:0 sc1
    v_mfma_f32_32x32x16_bf16 v[16:31], a[200:203], v[212:215], v[16:31]
    v_bitop3_b32 v135, v135, v227, v142 bitop3:0xf6
    v_bitop3_b32 v135, v135, v228, v142 bitop3:0xf6
    v_bitop3_b32 v135, v135, v229, v142 bitop3:0xf6
    v_mfma_f32_32x32x16_bf16 v[32:47], a[204:207], v[212:215], v[32:47]
    v_bitop3_b32 v135, v135, v230, v142 bitop3:0xf6
    v_bitop3_b32 v135, v135, v231, v142 bitop3:0xf6
    v_bitop3_b32 v135, v135, v232, v142 bitop3:0xf6
    buffer_load_dwordx4 v[180:183], v141, s[44:47], s78 offen offset:1024 sc1
    v_mfma_f32_32x32x16_bf16 v[16:31], a[208:211], v[216:219], v[16:31]
    v_bitop3_b32 v135, v135, v233, v142 bitop3:0xf6
    v_bitop3_b32 v135, v135, v234, v142 bitop3:0xf6
    v_bitop3_b32 v135, v135, v235, v142 bitop3:0xf6
    v_add_f32 v80, v80, v84
    v_add_f32 v81, v81, v85
    v_mfma_f32_32x32x16_bf16 v[32:47], a[212:215], v[216:219], v[32:47]
    v_bitop3_b32 v135, v135, v236, v142 bitop3:0xf6
    v_bitop3_b32 v135, v135, v237, v142 bitop3:0xf6
    v_bitop3_b32 v135, v135, v238, v142 bitop3:0xf6
    buffer_load_dwordx4 v[184:187], v141, s[44:47], s79 offen offset:0 sc1
    v_add_f32_e64 v82, v82, v86
    v_mfma_f32_32x32x16_bf16 v[16:31], a[216:219], v[220:223], v[16:31]
    v_bitop3_b32 v135, v135, v239, v142 bitop3:0xf6
    v_and_b32 v135, s96, v135
    v_cmp_ne_u32 vcc, 0, v135
    v_add_f32 v83, v83, v87
    v_add_f32 v80, v80, v81
    v_mfma_f32_32x32x16_bf16 v[32:47], a[220:223], v[220:223], v[32:47]
    s_cbranch_vccnz Lfs_7
Lfs_7_ret:
    buffer_load_dwordx4 v[188:191], v141, s[44:47], s79 offen offset:1024 sc1
    v_add_f32 v82, v82, v83
    v_add_f32 v98, v80, v82
    v_add_f32 v88, v88, v92
    v_mfma_f32_32x32x16_bf16 v[48:63], a[0:3], v[224:227], 0
    v_add_f32 v89, v89, v93
    v_add_f32 v90, v90, v94
    v_add_f32 v91, v91, v95
    v_add_f32 v88, v88, v89
    buffer_load_dwordx4 v[192:195], v141, s[44:47], s80 offen offset:0 sc1
    v_mfma_f32_32x32x16_bf16 v[64:79], a[4:7], v[224:227], 0
    s_waitcnt vmcnt(9)
    v_xor_b32 v135, v240, v142
    v_bitop3_b32 v135, v135, v241, v142 bitop3:0xf6
    v_bitop3_b32 v135, v135, v242, v142 bitop3:0xf6
    v_add_f32_e64 v90, v90, v91
    v_mfma_f32_32x32x16_bf16 v[48:63], a[8:11], v[228:231], v[48:63]
    buffer_load_dwordx4 v[196:199], v141, s[44:47], s80 offen offset:1024 sc1
    v_add_f32_e64 v99, v88, v90
    v_mul_f32 v96, 0x3b000000, v14
    v_mul_f32 v98, 0x3b000000, v98
    v_fma_f32 v98, -v96, v96, v98
    v_mul_f32 v97, 0x3b000000, v15
    v_mul_f32 v99, 0x3b000000, v99
    v_fma_f32 v99, -v97, v97, v99
    v_cvt_pk_bf16_f32 v100, v98, v99
    v_pk_max_i16 v100, v100, 0
    v_and_b32_e64 v99, s70, v100
    buffer_load_dwordx4 v[200:203], v141, s[44:47], s81 offen offset:0 sc1
    v_lshlrev_b32_e64 v98, 16, v100
    v_add_f32 v98, 0x3727c5ac, v98
    v_add_f32 v99, 0x3727c5ac, v99
    v_cvt_pk_bf16_f32 v100, v98, v99
    v_and_b32 v99, s70, v100
    v_lshlrev_b32 v98, 16, v100
    v_sqrt_f32 v98, v98
    v_sqrt_f32_e64 v99, v99
    s_nop 0
    buffer_load_dwordx4 v[204:207], v141, s[44:47], s81 offen offset:1024 sc1
    v_cvt_pk_bf16_f32 v100, v98, v99
    v_or_b32 v100, v100, v142
    v_and_b32 v99, s70, v100
    v_lshlrev_b32 v98, 16, v100
    v_rcp_f32 v136, v98
    v_rcp_f32 v137, v99
    s_nop 0
    ds_read_b64_tr_b16 v[84:85], v7 offset:0
    buffer_load_dwordx4 v[208:211], v141, s[44:47], s82 offen offset:0 sc1
    ds_read_b64_tr_b16 v[86:87], v7 offset:512
    s_waitcnt lgkmcnt(0)
    v_and_b32 v89, s70, v84
    v_lshlrev_b32 v88, 16, v84
    v_and_b32 v91, s70, v85
    v_lshlrev_b32 v90, 16, v85
    v_and_b32 v93, s70, v86
    v_lshlrev_b32 v92, 16, v86
    v_and_b32 v95, s70, v87
    v_lshlrev_b32_e64 v94, 16, v87
    v_bitop3_b32 v135, v135, v243, v142 bitop3:0xf6
    v_bitop3_b32 v135, v135, v244, v142 bitop3:0xf6
    v_bitop3_b32 v135, v135, v245, v142 bitop3:0xf6
    buffer_load_dwordx4 v[212:215], v141, s[44:47], s82 offen offset:1024 sc1
    v_mfma_f32_32x32x16_bf16 v[64:79], a[12:15], v[228:231], v[64:79]
    v_bitop3_b32 v135, v135, v246, v142 bitop3:0xf6
    v_bitop3_b32 v135, v135, v247, v142 bitop3:0xf6
    v_bitop3_b32 v135, v135, v248, v142 bitop3:0xf6
    s_nop 3
    v_mfma_f32_32x32x16_bf16 v[48:63], a[16:19], v[232:235], v[48:63]
    v_bitop3_b32 v135, v135, v249, v142 bitop3:0xf6
    v_bitop3_b32 v135, v135, v250, v142 bitop3:0xf6
    v_bitop3_b32 v135, v135, v251, v142 bitop3:0xf6
    buffer_load_dwordx4 v[216:219], v141, s[44:47], s83 offen offset:0 sc1
    ds_write_b128 v128, v[24:27] offset:2048
    v_mfma_f32_32x32x16_bf16 v[64:79], a[20:23], v[232:235], v[64:79]
    v_bitop3_b32 v135, v135, v252, v142 bitop3:0xf6
    v_bitop3_b32 v135, v135, v253, v142 bitop3:0xf6
    v_bitop3_b32 v135, v135, v254, v142 bitop3:0xf6
    buffer_load_dwordx4 v[220:223], v141, s[44:47], s83 offen offset:1024 sc1
    ds_write_b128 v128, v[28:31] offset:3072
    v_mfma_f32_32x32x16_bf16 v[48:63], a[24:27], v[236:239], v[48:63]
    v_bitop3_b32 v135, v135, v255, v142 bitop3:0xf6
    v_and_b32 v135, s96, v135
    v_cmp_ne_u32_e64 vcc, 0, v135
    ds_write_b128 v128, v[32:35] offset:4096
    v_mfma_f32_32x32x16_bf16 v[64:79], a[28:31], v[236:239], v[64:79]
    s_cbranch_vccnz Lfs_8
Lfs_8_ret:
    ds_write_b128 v128, v[36:39] offset:5120
    v_mfma_f32_32x32x16_bf16 v[48:63], a[32:35], v[240:243], v[48:63]
    buffer_load_dwordx4 v[224:227], v141, s[44:47], s84 offen offset:0 sc1
    ds_write_b128 v128, v[40:43] offset:6144
    v_mfma_f32_32x32x16_bf16 v[64:79], a[36:39], v[240:243], v[64:79]
    s_waitcnt vmcnt(13)
    v_xor_b32_e64 v135, v160, v142
    v_bitop3_b32 v135, v135, v161, v142 bitop3:0xf6
    v_bitop3_b32 v135, v135, v162, v142 bitop3:0xf6
    buffer_load_dwordx4 v[228:231], v141, s[44:47], s84 offen offset:1024 sc1
    v_mfma_f32_32x32x16_bf16 v[48:63], a[40:43], v[244:247], v[48:63]
    v_bitop3_b32 v135, v135, v163, v142 bitop3:0xf6
    v_bitop3_b32 v135, v135, v164, v142 bitop3:0xf6
    v_bitop3_b32 v135, v135, v165, v142 bitop3:0xf6
    ds_write_b128 v128, v[44:47] offset:7168
    v_mfma_f32_32x32x16_bf16 v[64:79], a[44:47], v[244:247], v[64:79]
    v_bitop3_b32 v135, v135, v166, v142 bitop3:0xf6
    v_bitop3_b32 v135, v135, v167, v142 bitop3:0xf6
    v_bitop3_b32 v135, v135, v168, v142 bitop3:0xf6
    buffer_load_dwordx4 v[232:235], v141, s[44:47], s85 offen offset:0 sc1
    v_mfma_f32_32x32x16_bf16 v[48:63], a[48:51], v[248:251], v[48:63]
    v_bitop3_b32 v135, v135, v169, v142 bitop3:0xf6
    v_bitop3_b32 v135, v135, v170, v142 bitop3:0xf6
    v_bitop3_b32 v135, v135, v171, v142 bitop3:0xf6
    v_mfma_f32_32x32x16_bf16 v[64:79], a[52:55], v[248:251], v[64:79]
    v_bitop3_b32 v135, v135, v172, v142 bitop3:0xf6
    v_bitop3_b32 v135, v135, v173, v142 bitop3:0xf6
    v_bitop3_b32 v135, v135, v174, v142 bitop3:0xf6
    buffer_load_dwordx4 v[236:239], v141, s[44:47], s85 offen offset:1024 sc1
    v_mfma_f32_32x32x16_bf16 v[48:63], a[56:59], v[252:255], v[48:63]
    v_bitop3_b32 v135, v135, v175, v142 bitop3:0xf6
    v_and_b32 v135, s96, v135
    v_cmp_ne_u32 vcc, 0, v135
    v_mfma_f32_32x32x16_bf16 v[64:79], a[60:63], v[252:255], v[64:79]
    s_cbranch_vccnz Lfs_9
Lfs_9_ret:
    v_mfma_f32_32x32x16_bf16 v[48:63], a[64:67], v[160:163], v[48:63]
    v_mfma_f32_32x32x16_bf16 v[64:79], a[68:71], v[160:163], v[64:79]
    s_waitcnt vmcnt(12)
    v_xor_b32_e64 v135, v176, v142
    v_bitop3_b32 v135, v135, v177, v142 bitop3:0xf6
    v_bitop3_b32 v135, v135, v178, v142 bitop3:0xf6
    v_mfma_f32_32x32x16_bf16 v[48:63], a[72:75], v[164:167], v[48:63]
    v_bitop3_b32 v135, v135, v179, v142 bitop3:0xf6
    v_bitop3_b32 v135, v135, v180, v142 bitop3:0xf6
    v_bitop3_b32 v135, v135, v181, v142 bitop3:0xf6
    s_waitcnt lgkmcnt(0)
    s_barrier
    v_mfma_f32_32x32x16_bf16 v[64:79], a[76:79], v[164:167], v[64:79]
    v_bitop3_b32 v135, v135, v182, v142 bitop3:0xf6
    v_bitop3_b32 v135, v135, v183, v142 bitop3:0xf6
    v_bitop3_b32 v135, v135, v184, v142 bitop3:0xf6
    ds_read_b128 v[24:27], v4 offset:2048
    ds_read_b128 v[28:31], v4 offset:3072
    v_mfma_f32_32x32x16_bf16 v[48:63], a[80:83], v[168:171], v[48:63]
    v_bitop3_b32 v135, v135, v185, v142 bitop3:0xf6
    v_bitop3_b32 v135, v135, v186, v142 bitop3:0xf6
    v_bitop3_b32 v135, v135, v187, v142 bitop3:0xf6
    ds_read_b128 v[32:35], v5 offset:4096
    ds_read_b128 v[36:39], v5 offset:5120
    v_mfma_f32_32x32x16_bf16 v[64:79], a[84:87], v[168:171], v[64:79]
    v_bitop3_b32 v135, v135, v188, v142 bitop3:0xf6
    v_bitop3_b32 v135, v135, v189, v142 bitop3:0xf6
    v_bitop3_b32 v135, v135, v190, v142 bitop3:0xf6
    ds_read_b128 v[40:43], v6 offset:6144
    ds_read_b128 v[44:47], v6 offset:7168
    v_mfma_f32_32x32x16_bf16 v[48:63], a[88:91], v[172:175], v[48:63]
    v_bitop3_b32 v135, v135, v191, v142 bitop3:0xf6
    v_and_b32 v135, s96, v135
    v_cmp_ne_u32 vcc, 0, v135
    v_mfma_f32_32x32x16_bf16 v[64:79], a[92:95], v[172:175], v[64:79]
    s_cbranch_vccnz Lfs_10
Lfs_10_ret:
    v_mfma_f32_32x32x16_bf16 v[48:63], a[96:99], v[176:179], v[48:63]
    v_mfma_f32_32x32x16_bf16 v[64:79], a[100:103], v[176:179], v[64:79]
    s_waitcnt vmcnt(8)
    v_xor_b32_e64 v135, v192, v142
    v_bitop3_b32 v135, v135, v193, v142 bitop3:0xf6
    v_bitop3_b32 v135, v135, v194, v142 bitop3:0xf6
    v_mfma_f32_32x32x16_bf16 v[48:63], a[104:107], v[180:183], v[48:63]
    v_bitop3_b32 v135, v135, v195, v142 bitop3:0xf6
    v_bitop3_b32 v135, v135, v196, v142 bitop3:0xf6
    v_bitop3_b32 v135, v135, v197, v142 bitop3:0xf6
    v_mfma_f32_32x32x16_bf16 v[64:79], a[108:111], v[180:183], v[64:79]
    v_bitop3_b32 v135, v135, v198, v142 bitop3:0xf6
    v_bitop3_b32 v135, v135, v199, v142 bitop3:0xf6
    v_bitop3_b32 v135, v135, v200, v142 bitop3:0xf6
    s_waitcnt lgkmcnt(0)
    v_add_f32 v16, v16, v24
    v_mfma_f32_32x32x16_bf16 v[48:63], a[112:115], v[184:187], v[48:63]
    v_bitop3_b32 v135, v135, v201, v142 bitop3:0xf6
    v_bitop3_b32 v135, v135, v202, v142 bitop3:0xf6
    v_bitop3_b32 v135, v135, v203, v142 bitop3:0xf6
    v_add_f32 v32, v32, v40
    v_add_f32 v16, v16, v32
    v_mfma_f32_32x32x16_bf16 v[64:79], a[116:119], v[184:187], v[64:79]
    v_bitop3_b32 v135, v135, v204, v142 bitop3:0xf6
    v_bitop3_b32 v135, v135, v205, v142 bitop3:0xf6
    v_bitop3_b32 v135, v135, v206, v142 bitop3:0xf6
    v_mul_f32 v16, v16, v136
    v_add_f32 v17, v17, v25
    v_mfma_f32_32x32x16_bf16 v[48:63], a[120:123], v[188:191], v[48:63]
    v_bitop3_b32 v135, v135, v207, v142 bitop3:0xf6
    v_and_b32 v135, s96, v135
    v_cmp_ne_u32 vcc, 0, v135
    v_add_f32 v33, v33, v41
    v_add_f32 v17, v17, v33
    v_mfma_f32_32x32x16_bf16 v[64:79], a[124:127], v[188:191], v[64:79]
    s_cbranch_vccnz Lfs_11
Lfs_11_ret:
    v_mul_f32 v17, v17, v136
    v_cvt_pk_bf16_f32 v16, v16, v17
    v_and_b32 v17, s70, v16
    v_lshlrev_b32 v16, 16, v16
    v_mfma_f32_32x32x16_bf16 v[48:63], a[128:131], v[192:195], v[48:63]
    v_add_f32 v16, v16, v88
    v_add_f32 v17, v17, v89
    v_cvt_pk_bf16_f32 v80, v16, v17
    v_add_f32 v18, v18, v26
    v_add_f32 v34, v34, v42
    v_mfma_f32_32x32x16_bf16 v[64:79], a[132:135], v[192:195], v[64:79]
    s_waitcnt vmcnt(4)
    v_xor_b32 v135, v208, v142
    v_bitop3_b32 v135, v135, v209, v142 bitop3:0xf6
    v_bitop3_b32 v135, v135, v210, v142 bitop3:0xf6
    v_add_f32_e64 v18, v18, v34
    v_mfma_f32_32x32x16_bf16 v[48:63], a[136:139], v[196:199], v[48:63]
    v_bitop3_b32 v135, v135, v211, v142 bitop3:0xf6
    v_bitop3_b32 v135, v135, v212, v142 bitop3:0xf6
    v_bitop3_b32 v135, v135, v213, v142 bitop3:0xf6
    v_mul_f32 v18, v18, v136
    v_add_f32 v19, v19, v27
    v_mfma_f32_32x32x16_bf16 v[64:79], a[140:143], v[196:199], v[64:79]
    v_bitop3_b32 v135, v135, v214, v142 bitop3:0xf6
    v_bitop3_b32 v135, v135, v215, v142 bitop3:0xf6
    v_bitop3_b32 v135, v135, v216, v142 bitop3:0xf6
    v_add_f32 v35, v35, v43
    v_add_f32 v19, v19, v35
    v_mfma_f32_32x32x16_bf16 v[48:63], a[144:147], v[200:203], v[48:63]
    v_bitop3_b32 v135, v135, v217, v142 bitop3:0xf6
    v_bitop3_b32 v135, v135, v218, v142 bitop3:0xf6
    v_bitop3_b32 v135, v135, v219, v142 bitop3:0xf6
    v_mul_f32_e64 v19, v19, v136
    v_cvt_pk_bf16_f32 v18, v18, v19
    v_mfma_f32_32x32x16_bf16 v[64:79], a[148:151], v[200:203], v[64:79]
    v_bitop3_b32 v135, v135, v220, v142 bitop3:0xf6
    v_bitop3_b32 v135, v135, v221, v142 bitop3:0xf6
    v_bitop3_b32 v135, v135, v222, v142 bitop3:0xf6
    v_and_b32 v19, s70, v18
    v_lshlrev_b32 v18, 16, v18
    v_mfma_f32_32x32x16_bf16 v[48:63], a[152:155], v[204:207], v[48:63]
    v_bitop3_b32 v135, v135, v223, v142 bitop3:0xf6
    v_and_b32 v135, s96, v135
    v_cmp_ne_u32 vcc, 0, v135
    v_add_f32 v18, v18, v90
    v_add_f32 v19, v19, v91
    v_mfma_f32_32x32x16_bf16 v[64:79], a[156:159], v[204:207], v[64:79]
    s_cbranch_vccnz Lfs_12
Lfs_12_ret:
    v_cvt_pk_bf16_f32 v81, v18, v19
    v_add_f32 v20, v20, v28
    v_add_f32 v36, v36, v44
    v_add_f32 v20, v20, v36
    v_mfma_f32_32x32x16_bf16 v[48:63], a[160:163], v[208:211], v[48:63]
    v_mul_f32 v20, v20, v136
    v_add_f32 v21, v21, v29
    v_add_f32 v37, v37, v45
    v_add_f32 v21, v21, v37
    v_mul_f32_e64 v21, v21, v136
    v_mfma_f32_32x32x16_bf16 v[64:79], a[164:167], v[208:211], v[64:79]
    s_waitcnt vmcnt(0)
    v_xor_b32 v135, v224, v142
    v_bitop3_b32 v135, v135, v225, v142 bitop3:0xf6
    v_bitop3_b32 v135, v135, v226, v142 bitop3:0xf6
    v_cvt_pk_bf16_f32 v20, v20, v21
    v_mfma_f32_32x32x16_bf16 v[48:63], a[168:171], v[212:215], v[48:63]
    v_bitop3_b32 v135, v135, v227, v142 bitop3:0xf6
    v_bitop3_b32 v135, v135, v228, v142 bitop3:0xf6
    v_bitop3_b32 v135, v135, v229, v142 bitop3:0xf6
    v_and_b32 v21, s70, v20
    v_lshlrev_b32 v20, 16, v20
    v_mfma_f32_32x32x16_bf16 v[64:79], a[172:175], v[212:215], v[64:79]
    v_bitop3_b32 v135, v135, v230, v142 bitop3:0xf6
    v_bitop3_b32 v135, v135, v231, v142 bitop3:0xf6
    v_bitop3_b32 v135, v135, v232, v142 bitop3:0xf6
    v_add_f32 v20, v20, v92
    v_add_f32 v21, v21, v93
    v_mfma_f32_32x32x16_bf16 v[48:63], a[176:179], v[216:219], v[48:63]
    v_bitop3_b32 v135, v135, v233, v142 bitop3:0xf6
    v_bitop3_b32 v135, v135, v234, v142 bitop3:0xf6
    v_bitop3_b32 v135, v135, v235, v142 bitop3:0xf6
    v_cvt_pk_bf16_f32 v82, v20, v21
    v_add_f32_e64 v22, v22, v30
    v_mfma_f32_32x32x16_bf16 v[64:79], a[180:183], v[216:219], v[64:79]
    v_bitop3_b32 v135, v135, v236, v142 bitop3:0xf6
    v_bitop3_b32 v135, v135, v237, v142 bitop3:0xf6
    v_bitop3_b32 v135, v135, v238, v142 bitop3:0xf6
    v_add_f32 v38, v38, v46
    v_add_f32 v22, v22, v38
    v_mfma_f32_32x32x16_bf16 v[48:63], a[184:187], v[220:223], v[48:63]
    v_bitop3_b32 v135, v135, v239, v142 bitop3:0xf6
    v_and_b32 v135, s96, v135
    v_cmp_ne_u32 vcc, 0, v135
    v_mul_f32 v22, v22, v136
    v_add_f32 v23, v23, v31
    v_mfma_f32_32x32x16_bf16 v[64:79], a[188:191], v[220:223], v[64:79]
    s_cbranch_vccnz Lfs_13
Lfs_13_ret:
    v_add_f32 v39, v39, v47
    v_add_f32 v23, v23, v39
    v_mul_f32 v23, v23, v136
    v_cvt_pk_bf16_f32 v22, v22, v23
    v_and_b32 v23, s70, v22
    v_lshlrev_b32 v22, 16, v22
    v_add_f32 v22, v22, v94
    v_add_f32 v23, v23, v95
    v_cvt_pk_bf16_f32 v83, v22, v23
    s_nop 1
    v_permlane32_swap_b32 v80, v82
    v_permlane32_swap_b32 v81, v83
    s_nop 0
    buffer_store_dwordx4 v[80:83], v2, s[60:63], s88 offen
    v_add_u32 v128, 65536, v128
    v_add_u32 v4, 65536, v4
    v_add_u32 v5, 65536, v5
    v_add_u32 v6, 65536, v6
    v_add_u32 v7, 65536, v7
    ds_read_b64_tr_b16 v[84:85], v7 offset:0
    ds_read_b64_tr_b16 v[86:87], v7 offset:512
    s_waitcnt lgkmcnt(0)
    v_and_b32 v89, s70, v84
    v_lshlrev_b32 v88, 16, v84
    v_and_b32 v91, s70, v85
    v_lshlrev_b32 v90, 16, v85
    v_and_b32 v93, s70, v86
    v_lshlrev_b32 v92, 16, v86
    v_and_b32 v95, s70, v87
    v_lshlrev_b32_e64 v94, 16, v87
    v_mfma_f32_32x32x16_bf16 v[64:79], a[196:199], v[224:227], v[64:79]
    v_mfma_f32_32x32x16_bf16 v[64:79], a[204:207], v[228:231], v[64:79]
    v_mfma_f32_32x32x16_bf16 v[64:79], a[212:215], v[232:235], v[64:79]
    v_mfma_f32_32x32x16_bf16 v[64:79], a[220:223], v[236:239], v[64:79]
    v_mfma_f32_32x32x16_bf16 v[48:63], a[192:195], v[224:227], v[48:63]
    s_nop 10
    ds_write_b128 v128, v[64:67] offset:4096
    v_mfma_f32_32x32x16_bf16 v[48:63], a[200:203], v[228:231], v[48:63]
    ds_write_b128 v128, v[68:71] offset:5120
    v_mfma_f32_32x32x16_bf16 v[48:63], a[208:211], v[232:235], v[48:63]
    ds_write_b128 v128, v[72:75] offset:6144
    v_mfma_f32_32x32x16_bf16 v[48:63], a[216:219], v[236:239], v[48:63]
    ds_write_b128 v128, v[76:79] offset:7168
    s_nop 10
    ds_write_b128 v128, v[56:59] offset:2048
    ds_write_b128 v128, v[60:63] offset:3072
    s_waitcnt lgkmcnt(0)
    s_barrier
    ds_read_b128 v[56:59], v4 offset:2048
    ds_read_b128 v[60:63], v4 offset:3072
    ds_read_b128 v[64:67], v5 offset:4096
    ds_read_b128 v[68:71], v5 offset:5120
    ds_read_b128 v[72:75], v6 offset:6144
    ds_read_b128 v[76:79], v6 offset:7168
    s_waitcnt lgkmcnt(0)
    s_nop 0
    v_pk_add_f32 v[48:49], v[48:49], v[56:57]
    v_pk_add_f32 v[64:65], v[64:65], v[72:73]
    v_pk_add_f32 v[48:49], v[48:49], v[64:65]
    v_pk_mul_f32 v[48:49], v[48:49], v[136:137] op_sel:[0,1] op_sel_hi:[1,1]
    v_cvt_pk_bf16_f32 v48, v48, v49
    v_and_b32 v49, s70, v48
    v_lshlrev_b32 v48, 16, v48
    v_pk_add_f32 v[48:49], v[48:49], v[88:89]
    v_cvt_pk_bf16_f32 v80, v48, v49
    v_pk_add_f32 v[50:51], v[50:51], v[58:59]
    v_pk_add_f32 v[66:67], v[66:67], v[74:75]
    v_pk_add_f32 v[50:51], v[50:51], v[66:67]
    v_pk_mul_f32 v[50:51], v[50:51], v[136:137] op_sel:[0,1] op_sel_hi:[1,1]
    v_cvt_pk_bf16_f32 v50, v50, v51
    v_and_b32 v51, s70, v50
    v_lshlrev_b32 v50, 16, v50
    v_pk_add_f32 v[50:51], v[50:51], v[90:91]
    v_cvt_pk_bf16_f32 v81, v50, v51
    v_pk_add_f32 v[52:53], v[52:53], v[60:61]
    v_pk_add_f32 v[68:69], v[68:69], v[76:77]
    v_pk_add_f32 v[52:53], v[52:53], v[68:69]
    v_pk_mul_f32 v[52:53], v[52:53], v[136:137] op_sel:[0,1] op_sel_hi:[1,1]
    v_cvt_pk_bf16_f32 v52, v52, v53
    v_and_b32 v53, s70, v52
    v_lshlrev_b32 v52, 16, v52
    v_pk_add_f32 v[52:53], v[52:53], v[92:93]
    v_cvt_pk_bf16_f32 v82, v52, v53
    v_pk_add_f32 v[54:55], v[54:55], v[62:63]
    v_pk_add_f32 v[70:71], v[70:71], v[78:79]
    v_pk_add_f32 v[54:55], v[54:55], v[70:71]
    v_pk_mul_f32 v[54:55], v[54:55], v[136:137] op_sel:[0,1] op_sel_hi:[1,1]
    v_cvt_pk_bf16_f32 v54, v54, v55
    v_and_b32 v55, s70, v54
    v_lshlrev_b32 v54, 16, v54
    v_pk_add_f32 v[54:55], v[54:55], v[94:95]
    v_cvt_pk_bf16_f32 v83, v54, v55
    s_nop 1
    v_permlane32_swap_b32 v80, v82
    v_permlane32_swap_b32 v81, v83
    buffer_store_dwordx4 v[80:83], v2, s[60:63], s89 offen
Lend:
    s_endpgm
LpA:
    s_add_u32 s97, s97, 1
    s_cmp_ge_u32 s97, 50000
    s_cbranch_scc1 LpA_ret
    s_add_u32 s10, s49, 0
    s_nop 0
    buffer_load_dwordx4 v[72:75], v141, s[44:47], s10 offen sc1
    s_mov_b32 s10, 13631488
    buffer_load_dwordx4 v[76:79], v110, s[44:47], s10 offen sc1
    s_add_u32 s10, s49, 1048576
    buffer_load_dwordx4 v[80:83], v141, s[44:47], s10 offen sc1
    s_mov_b32 s10, 13635584
    buffer_load_dwordx4 v[84:87], v110, s[44:47], s10 offen sc1
    s_waitcnt vmcnt(0)
    v_xor_b32 v88, s68, v74
    v_bitop3_b32 v88, v88, v79, s68 bitop3:0xf6
    v_bitop3_b32 v88, v88, v82, s68 bitop3:0xf6
    v_bitop3_b32 v88, v88, v87, s68 bitop3:0xf6
    v_bitop3_b32 v88, v88, v75, s69 bitop3:0xf6
    v_bitop3_b32 v88, v88, v83, s69 bitop3:0xf6
    v_cmp_ne_u32 vcc, 0, v88
    s_cbranch_vccnz LpA
    s_branch LpA_ret
LpB:
    s_add_u32 s97, s97, 1
    s_cmp_ge_u32 s97, 50000
    s_cbranch_scc1 LpB_ret
    s_nop 0
    s_add_u32 s10, s49, 2097152
    buffer_load_dwordx4 v[92:95], v141, s[44:47], s10 offen sc1
    s_mov_b32 s10, 13639680
    buffer_load_dwordx4 v[96:99], v110, s[44:47], s10 offen sc1
    s_add_u32 s10, s49, 3145728
    buffer_load_dwordx4 v[100:103], v141, s[44:47], s10 offen sc1
    s_mov_b32 s10, 13643776
    buffer_load_dwordx4 v[104:107], v110, s[44:47], s10 offen sc1
    s_waitcnt vmcnt(0)
    v_xor_b32 v60, s68, v94
    v_bitop3_b32 v60, v60, v99, s68 bitop3:0xf6
    v_bitop3_b32 v60, v60, v102, s68 bitop3:0xf6
    v_bitop3_b32 v60, v60, v107, s68 bitop3:0xf6
    v_bitop3_b32 v60, v60, v95, s69 bitop3:0xf6
    v_bitop3_b32 v60, v60, v103, s69 bitop3:0xf6
    v_cmp_ne_u32 vcc, 0, v60
    s_cbranch_vccnz LpB
    s_branch LpB_ret
Lep:
    v_mov_b32 v120, s68
    v_mov_b32 v121, 13697024
    buffer_store_dword v120, v121, s[44:47], 0 offen
    s_branch Lep_ret
Lhs_0:
    s_mov_b32 s12, m0
    s_mov_b32 s13, s100
Lhs_0_l:
    s_add_u32 s91, s91, 1
    s_cmp_ge_u32 s91, 50000
    s_cbranch_scc1 Lhs_0_x
    s_mov_b32 m0, s38
    s_mov_b32 s100, s92
    s_nop 0
    buffer_load_dwordx4 v1, s[44:47], s100 offen offset:0 sc1 lds
    buffer_load_dwordx4 v1, s[44:47], s100 offen offset:1024 sc1 lds
    buffer_load_dwordx4 v1, s[44:47], s100 offen offset:2048 sc1 lds
    buffer_load_dwordx4 v1, s[44:47], s100 offen offset:3072 sc1 lds
    s_waitcnt vmcnt(0)
    s_nop 0
    ds_read_b64_tr_b16 v[36:37], v13 offset:0
    ds_read_b64_tr_b16 v[38:39], v13 offset:512
    ds_read_b64_tr_b16 v[40:41], v13 offset:1024
    ds_read_b64_tr_b16 v[42:43], v13 offset:1536
    ds_read_b64_tr_b16 v[44:45], v13 offset:2048
    ds_read_b64_tr_b16 v[46:47], v13 offset:2560
    ds_read_b64_tr_b16 v[134:135], v13 offset:3072
    ds_read_b64_tr_b16 v[136:137], v13 offset:3584
    s_waitcnt lgkmcnt(0)
    v_mfma_f32_16x16x32_bf16 v[156:159], v[144:147], v[36:39], 0
    v_mfma_f32_16x16x32_bf16 v[156:159], v[144:147], v[40:43], v[156:159]
    v_mfma_f32_16x16x32_bf16 v[156:159], v[144:147], v[44:47], v[156:159]
    v_mfma_f32_16x16x32_bf16 v[156:159], v[144:147], v[134:137], v[156:159]
    s_nop 7
    v_cmp_u_f32 vcc, v156, v157
    s_cbranch_vccnz Lhs_0_l
Lhs_0_x:
    s_mov_b32 m0, s12
    s_mov_b32 s100, s13
    s_branch Lhs_0_ret
Lhs_1:
    s_mov_b32 s12, m0
    s_mov_b32 s13, s100
Lhs_1_l:
    s_add_u32 s91, s91, 1
    s_cmp_ge_u32 s91, 50000
    s_cbranch_scc1 Lhs_1_x
    s_mov_b32 m0, s39
    s_mov_b32 s100, s93
    s_nop 0
    buffer_load_dwordx4 v1, s[44:47], s100 offen offset:0 sc1 lds
    buffer_load_dwordx4 v1, s[44:47], s100 offen offset:1024 sc1 lds
    buffer_load_dwordx4 v1, s[44:47], s100 offen offset:2048 sc1 lds
    buffer_load_dwordx4 v1, s[44:47], s100 offen offset:3072 sc1 lds
    s_waitcnt vmcnt(0)
    s_nop 0
    ds_read_b64_tr_b16 v[36:37], v13 offset:4096
    ds_read_b64_tr_b16 v[38:39], v13 offset:4608
    ds_read_b64_tr_b16 v[40:41], v13 offset:5120
    ds_read_b64_tr_b16 v[42:43], v13 offset:5632
    ds_read_b64_tr_b16 v[44:45], v13 offset:6144
    ds_read_b64_tr_b16 v[46:47], v13 offset:6656
    ds_read_b64_tr_b16 v[134:135], v13 offset:7168
    ds_read_b64_tr_b16 v[136:137], v13 offset:7680
    s_waitcnt lgkmcnt(0)
    v_mfma_f32_16x16x32_bf16 v[130:133], v[144:147], v[36:39], v[156:159]
    v_mfma_f32_16x16x32_bf16 v[130:133], v[144:147], v[40:43], v[130:133]
    v_mfma_f32_16x16x32_bf16 v[130:133], v[144:147], v[44:47], v[130:133]
    v_mfma_f32_16x16x32_bf16 v[130:133], v[144:147], v[134:137], v[130:133]
    s_nop 7
    v_cmp_u_f32 vcc, v130, v131
    s_cbranch_vccnz Lhs_1_l
Lhs_1_x:
    s_mov_b32 m0, s12
    s_mov_b32 s100, s13
    s_branch Lhs_1_ret
Lhs_2:
    s_mov_b32 s12, m0
    s_mov_b32 s13, s100
Lhs_2_l:
    s_add_u32 s91, s91, 1
    s_cmp_ge_u32 s91, 50000
    s_cbranch_scc1 Lhs_2_x
    s_mov_b32 m0, s40
    s_mov_b32 s100, s94
    s_nop 0
    buffer_load_dwordx4 v1, s[44:47], s100 offen offset:0 sc1 lds
    buffer_load_dwordx4 v1, s[44:47], s100 offen offset:1024 sc1 lds
    buffer_load_dwordx4 v1, s[44:47], s100 offen offset:2048 sc1 lds
    buffer_load_dwordx4 v1, s[44:47], s100 offen offset:3072 sc1 lds
    s_waitcnt vmcnt(0)
    s_nop 0
    ds_read_b64_tr_b16 v[36:37], v13 offset:8192
    ds_read_b64_tr_b16 v[38:39], v13 offset:8704
    ds_read_b64_tr_b16 v[40:41], v13 offset:9216
    ds_read_b64_tr_b16 v[42:43], v13 offset:9728
    ds_read_b64_tr_b16 v[44:45], v13 offset:10240
    ds_read_b64_tr_b16 v[46:47], v13 offset:10752
    ds_read_b64_tr_b16 v[134:135], v13 offset:11264
    ds_read_b64_tr_b16 v[136:137], v13 offset:11776
    s_waitcnt lgkmcnt(0)
    v_mfma_f32_16x16x32_bf16 v[156:159], v[144:147], v[36:39], 0
    v_mfma_f32_16x16x32_bf16 v[156:159], v[144:147], v[40:43], v[156:159]
    v_mfma_f32_16x16x32_bf16 v[156:159], v[144:147], v[44:47], v[156:159]
    v_mfma_f32_16x16x32_bf16 v[156:159], v[144:147], v[134:137], v[156:159]
    s_nop 7
    v_cmp_u_f32 vcc, v156, v157
    s_cbranch_vccnz Lhs_2_l
Lhs_2_x:
    s_mov_b32 m0, s12
    s_mov_b32 s100, s13
    s_branch Lhs_2_ret
Lhs_3:
    s_mov_b32 s12, m0
    s_mov_b32 s13, s100
Lhs_3_l:
    s_add_u32 s91, s91, 1
    s_cmp_ge_u32 s91, 50000
    s_cbranch_scc1 Lhs_3_x
    s_mov_b32 m0, s41
    s_mov_b32 s100, s95
    s_nop 0
    buffer_load_dwordx4 v1, s[44:47], s100 offen offset:0 sc1 lds
    buffer_load_dwordx4 v1, s[44:47], s100 offen offset:1024 sc1 lds
    buffer_load_dwordx4 v1, s[44:47], s100 offen offset:2048 sc1 lds
    buffer_load_dwordx4 v1, s[44:47], s100 offen offset:3072 sc1 lds
    s_waitcnt vmcnt(0)
    s_nop 0
    ds_read_b64_tr_b16 v[36:37], v13 offset:12288
    ds_read_b64_tr_b16 v[38:39], v13 offset:12800
    ds_read_b64_tr_b16 v[40:41], v13 offset:13312
    ds_read_b64_tr_b16 v[42:43], v13 offset:13824
    ds_read_b64_tr_b16 v[44:45], v13 offset:14336
    ds_read_b64_tr_b16 v[46:47], v13 offset:14848
    ds_read_b64_tr_b16 v[134:135], v13 offset:15360
    ds_read_b64_tr_b16 v[136:137], v13 offset:15872
    s_waitcnt lgkmcnt(0)
    v_mfma_f32_16x16x32_bf16 v[130:133], v[144:147], v[36:39], v[156:159]
    v_mfma_f32_16x16x32_bf16 v[130:133], v[144:147], v[40:43], v[130:133]
    v_mfma_f32_16x16x32_bf16 v[130:133], v[144:147], v[44:47], v[130:133]
    v_mfma_f32_16x16x32_bf16 v[130:133], v[144:147], v[134:137], v[130:133]
    s_nop 7
    v_cmp_u_f32 vcc, v130, v131
    s_cbranch_vccnz Lhs_3_l
Lhs_3_x:
    s_mov_b32 m0, s12
    s_mov_b32 s100, s13
    s_branch Lhs_3_ret
Lhs_4:
    s_mov_b32 s12, m0
    s_mov_b32 s13, s100
Lhs_4_l:
    s_add_u32 s91, s91, 1
    s_cmp_ge_u32 s91, 50000
    s_cbranch_scc1 Lhs_4_x
    s_nop 0
    s_or_b32 m0, s38, 65536
    s_add_u32 s100, s92, 0x100000
    buffer_load_dwordx4 v1, s[44:47], s100 offen offset:0 sc1 lds
    buffer_load_dwordx4 v1, s[44:47], s100 offen offset:1024 sc1 lds
    buffer_load_dwordx4 v1, s[44:47], s100 offen offset:2048 sc1 lds
    buffer_load_dwordx4 v1, s[44:47], s100 offen offset:3072 sc1 lds
    s_waitcnt vmcnt(0)
    s_nop 0
    ds_read_b64_tr_b16 v[36:37], v139 offset:0
    ds_read_b64_tr_b16 v[38:39], v139 offset:512
    ds_read_b64_tr_b16 v[40:41], v139 offset:1024
    ds_read_b64_tr_b16 v[42:43], v139 offset:1536
    ds_read_b64_tr_b16 v[44:45], v139 offset:2048
    ds_read_b64_tr_b16 v[46:47], v139 offset:2560
    ds_read_b64_tr_b16 v[134:135], v139 offset:3072
    ds_read_b64_tr_b16 v[136:137], v139 offset:3584
    s_waitcnt lgkmcnt(0)
    v_mfma_f32_16x16x32_bf16 v[156:159], v[144:147], v[36:39], 0
    v_mfma_f32_16x16x32_bf16 v[156:159], v[144:147], v[40:43], v[156:159]
    v_mfma_f32_16x16x32_bf16 v[156:159], v[144:147], v[44:47], v[156:159]
    v_mfma_f32_16x16x32_bf16 v[156:159], v[144:147], v[134:137], v[156:159]
    s_nop 7
    v_cmp_u_f32 vcc, v156, v157
    s_cbranch_vccnz Lhs_4_l
Lhs_4_x:
    s_mov_b32 m0, s12
    s_mov_b32 s100, s13
    s_branch Lhs_4_ret
Lhs_5:
    s_mov_b32 s12, m0
    s_mov_b32 s13, s100
Lhs_5_l:
    s_add_u32 s91, s91, 1
    s_cmp_ge_u32 s91, 50000
    s_cbranch_scc1 Lhs_5_x
    s_nop 0
    s_or_b32 m0, s39, 65536
    s_add_u32 s100, s93, 0x100000
    buffer_load_dwordx4 v1, s[44:47], s100 offen offset:0 sc1 lds
    buffer_load_dwordx4 v1, s[44:47], s100 offen offset:1024 sc1 lds
    buffer_load_dwordx4 v1, s[44:47], s100 offen offset:2048 sc1 lds
    buffer_load_dwordx4 v1, s[44:47], s100 offen offset:3072 sc1 lds
    s_waitcnt vmcnt(0)
    s_nop 0
    ds_read_b64_tr_b16 v[36:37], v139 offset:4096
    ds_read_b64_tr_b16 v[38:39], v139 offset:4608
    ds_read_b64_tr_b16 v[40:41], v139 offset:5120
    ds_read_b64_tr_b16 v[42:43], v139 offset:5632
    ds_read_b64_tr_b16 v[44:45], v139 offset:6144
    ds_read_b64_tr_b16 v[46:47], v139 offset:6656
    ds_read_b64_tr_b16 v[134:135], v139 offset:7168
    ds_read_b64_tr_b16 v[136:137], v139 offset:7680
    s_waitcnt lgkmcnt(0)
    v_mfma_f32_16x16x32_bf16 v[130:133], v[144:147], v[36:39], v[156:159]
    v_mfma_f32_16x16x32_bf16 v[130:133], v[144:147], v[40:43], v[130:133]
    v_mfma_f32_16x16x32_bf16 v[130:133], v[144:147], v[44:47], v[130:133]
    v_mfma_f32_16x16x32_bf16 v[130:133], v[144:147], v[134:137], v[130:133]
    s_nop 7
    v_cmp_u_f32 vcc, v130, v131
    s_cbranch_vccnz Lhs_5_l
Lhs_5_x:
    s_mov_b32 m0, s12
    s_mov_b32 s100, s13
    s_branch Lhs_5_ret
Lhs_6:
    s_mov_b32 s12, m0
    s_mov_b32 s13, s100
Lhs_6_l:
    s_add_u32 s91, s91, 1
    s_cmp_ge_u32 s91, 50000
    s_cbranch_scc1 Lhs_6_x
    s_nop 0
    s_or_b32 m0, s40, 65536
    s_add_u32 s100, s94, 0x100000
    buffer_load_dwordx4 v1, s[44:47], s100 offen offset:0 sc1 lds
    buffer_load_dwordx4 v1, s[44:47], s100 offen offset:1024 sc1 lds
    buffer_load_dwordx4 v1, s[44:47], s100 offen offset:2048 sc1 lds
    buffer_load_dwordx4 v1, s[44:47], s100 offen offset:3072 sc1 lds
    s_waitcnt vmcnt(0)
    s_nop 0
    ds_read_b64_tr_b16 v[36:37], v139 offset:8192
    ds_read_b64_tr_b16 v[38:39], v139 offset:8704
    ds_read_b64_tr_b16 v[40:41], v139 offset:9216
    ds_read_b64_tr_b16 v[42:43], v139 offset:9728
    ds_read_b64_tr_b16 v[44:45], v139 offset:10240
    ds_read_b64_tr_b16 v[46:47], v139 offset:10752
    ds_read_b64_tr_b16 v[134:135], v139 offset:11264
    ds_read_b64_tr_b16 v[136:137], v139 offset:11776
    s_waitcnt lgkmcnt(0)
    v_mfma_f32_16x16x32_bf16 v[156:159], v[144:147], v[36:39], 0
    v_mfma_f32_16x16x32_bf16 v[156:159], v[144:147], v[40:43], v[156:159]
    v_mfma_f32_16x16x32_bf16 v[156:159], v[144:147], v[44:47], v[156:159]
    v_mfma_f32_16x16x32_bf16 v[156:159], v[144:147], v[134:137], v[156:159]
    s_nop 7
    v_cmp_u_f32 vcc, v156, v157
    s_cbranch_vccnz Lhs_6_l
Lhs_6_x:
    s_mov_b32 m0, s12
    s_mov_b32 s100, s13
    s_branch Lhs_6_ret
Lhs_7:
    s_mov_b32 s12, m0
    s_mov_b32 s13, s100
Lhs_7_l:
    s_add_u32 s91, s91, 1
    s_cmp_ge_u32 s91, 50000
    s_cbranch_scc1 Lhs_7_x
    s_nop 0
    s_or_b32 m0, s41, 65536
    s_add_u32 s100, s95, 0x100000
    buffer_load_dwordx4 v1, s[44:47], s100 offen offset:0 sc1 lds
    buffer_load_dwordx4 v1, s[44:47], s100 offen offset:1024 sc1 lds
    buffer_load_dwordx4 v1, s[44:47], s100 offen offset:2048 sc1 lds
    buffer_load_dwordx4 v1, s[44:47], s100 offen offset:3072 sc1 lds
    s_waitcnt vmcnt(0)
    s_nop 0
    ds_read_b64_tr_b16 v[36:37], v139 offset:12288
    ds_read_b64_tr_b16 v[38:39], v139 offset:12800
    ds_read_b64_tr_b16 v[40:41], v139 offset:13312
    ds_read_b64_tr_b16 v[42:43], v139 offset:13824
    ds_read_b64_tr_b16 v[44:45], v139 offset:14336
    ds_read_b64_tr_b16 v[46:47], v139 offset:14848
    ds_read_b64_tr_b16 v[134:135], v139 offset:15360
    ds_read_b64_tr_b16 v[136:137], v139 offset:15872
    s_waitcnt lgkmcnt(0)
    v_mfma_f32_16x16x32_bf16 v[130:133], v[144:147], v[36:39], v[156:159]
    v_mfma_f32_16x16x32_bf16 v[130:133], v[144:147], v[40:43], v[130:133]
    v_mfma_f32_16x16x32_bf16 v[130:133], v[144:147], v[44:47], v[130:133]
    v_mfma_f32_16x16x32_bf16 v[130:133], v[144:147], v[134:137], v[130:133]
    s_nop 7
    v_cmp_u_f32 vcc, v130, v131
    s_cbranch_vccnz Lhs_7_l
Lhs_7_x:
    s_mov_b32 m0, s12
    s_mov_b32 s100, s13
    s_branch Lhs_7_ret
Lfs_0:
    s_add_u32 s97, s97, 1
    s_cmp_ge_u32 s97, 50000
    s_cbranch_scc1 Lfs_0_ret
    s_nop 0
    buffer_load_dwordx4 v[80:83], v1, s[44:47], s72 offen offset:0 sc1
    buffer_load_dwordx4 v[84:87], v1, s[44:47], s72 offen offset:1024 sc1
    buffer_load_dwordx4 v[88:91], v1, s[44:47], s73 offen offset:0 sc1
    buffer_load_dwordx4 v[92:95], v1, s[44:47], s73 offen offset:1024 sc1
    buffer_load_dwordx4 v[96:99], v1, s[44:47], s74 offen offset:0 sc1
    buffer_load_dwordx4 v[100:103], v1, s[44:47], s74 offen offset:1024 sc1
    buffer_load_dwordx4 v[104:107], v1, s[44:47], s75 offen offset:0 sc1
    buffer_load_dwordx4 v[108:111], v1, s[44:47], s75 offen offset:1024 sc1
    buffer_load_dwordx4 v[112:115], v1, s[44:47], s76 offen offset:0 sc1
    buffer_load_dwordx4 v[116:119], v1, s[44:47], s76 offen offset:1024 sc1
    buffer_load_dwordx4 v[120:123], v1, s[44:47], s77 offen offset:0 sc1
    buffer_load_dwordx4 v[124:127], v1, s[44:47], s77 offen offset:1024 sc1
    s_waitcnt vmcnt(0)
    v_xor_b32 v135, v80, v142
    v_bitop3_b32 v135, v135, v81, v142 bitop3:0xf6
    v_bitop3_b32 v135, v135, v82, v142 bitop3:0xf6
    v_bitop3_b32 v135, v135, v83, v142 bitop3:0xf6
    v_bitop3_b32 v135, v135, v84, v142 bitop3:0xf6
    v_bitop3_b32 v135, v135, v85, v142 bitop3:0xf6
    v_bitop3_b32 v135, v135, v86, v142 bitop3:0xf6
    v_bitop3_b32 v135, v135, v87, v142 bitop3:0xf6
    v_bitop3_b32 v135, v135, v88, v142 bitop3:0xf6
    v_bitop3_b32 v135, v135, v89, v142 bitop3:0xf6
    v_bitop3_b32 v135, v135, v90, v142 bitop3:0xf6
    v_bitop3_b32 v135, v135, v91, v142 bitop3:0xf6
    v_bitop3_b32 v135, v135, v92, v142 bitop3:0xf6
    v_bitop3_b32 v135, v135, v93, v142 bitop3:0xf6
    v_bitop3_b32 v135, v135, v94, v142 bitop3:0xf6
    v_bitop3_b32 v135, v135, v95, v142 bitop3:0xf6
    v_and_b32 v135, s96, v135
    v_cmp_ne_u32_e64 vcc, 0, v135
    s_cbranch_vccnz Lfs_0
    s_branch Lfs_0_ret
Lfs_1:
    s_add_u32 s97, s97, 1
    s_cmp_ge_u32 s97, 50000
    s_cbranch_scc1 Lfs_1_ret
    s_nop 0
    buffer_load_dwordx4 v[96:99], v1, s[44:47], s74 offen offset:0 sc1
    buffer_load_dwordx4 v[100:103], v1, s[44:47], s74 offen offset:1024 sc1
    buffer_load_dwordx4 v[104:107], v1, s[44:47], s75 offen offset:0 sc1
    buffer_load_dwordx4 v[108:111], v1, s[44:47], s75 offen offset:1024 sc1
    buffer_load_dwordx4 v[112:115], v1, s[44:47], s76 offen offset:0 sc1
    buffer_load_dwordx4 v[116:119], v1, s[44:47], s76 offen offset:1024 sc1
    buffer_load_dwordx4 v[120:123], v1, s[44:47], s77 offen offset:0 sc1
    buffer_load_dwordx4 v[124:127], v1, s[44:47], s77 offen offset:1024 sc1
    buffer_load_dwordx4 v[160:163], v1, s[44:47], s78 offen offset:0 sc1
    buffer_load_dwordx4 v[164:167], v1, s[44:47], s78 offen offset:1024 sc1
    buffer_load_dwordx4 v[168:171], v1, s[44:47], s79 offen offset:0 sc1
    buffer_load_dwordx4 v[172:175], v1, s[44:47], s79 offen offset:1024 sc1
    s_waitcnt vmcnt(0)
    v_xor_b32 v135, v96, v142
    v_bitop3_b32 v135, v135, v97, v142 bitop3:0xf6
    v_bitop3_b32 v135, v135, v98, v142 bitop3:0xf6
    v_bitop3_b32 v135, v135, v99, v142 bitop3:0xf6
    v_bitop3_b32 v135, v135, v100, v142 bitop3:0xf6
    v_bitop3_b32 v135, v135, v101, v142 bitop3:0xf6
    v_bitop3_b32 v135, v135, v102, v142 bitop3:0xf6
    v_bitop3_b32 v135, v135, v103, v142 bitop3:0xf6
    v_bitop3_b32 v135, v135, v104, v142 bitop3:0xf6
    v_bitop3_b32 v135, v135, v105, v142 bitop3:0xf6
    v_bitop3_b32 v135, v135, v106, v142 bitop3:0xf6
    v_bitop3_b32 v135, v135, v107, v142 bitop3:0xf6
    v_bitop3_b32 v135, v135, v108, v142 bitop3:0xf6
    v_bitop3_b32 v135, v135, v109, v142 bitop3:0xf6
    v_bitop3_b32 v135, v135, v110, v142 bitop3:0xf6
    v_bitop3_b32 v135, v135, v111, v142 bitop3:0xf6
    v_and_b32 v135, s96, v135
    v_cmp_ne_u32_e64 vcc, 0, v135
    s_cbranch_vccnz Lfs_1
    s_branch Lfs_1_ret
Lfs_2:
    s_add_u32 s97, s97, 1
    s_cmp_ge_u32 s97, 50000
    s_cbranch_scc1 Lfs_2_ret
    s_nop 0
    buffer_load_dwordx4 v[112:115], v1, s[44:47], s76 offen offset:0 sc1
    buffer_load_dwordx4 v[116:119], v1, s[44:47], s76 offen offset:1024 sc1
    buffer_load_dwordx4 v[120:123], v1, s[44:47], s77 offen offset:0 sc1
    buffer_load_dwordx4 v[124:127], v1, s[44:47], s77 offen offset:1024 sc1
    buffer_load_dwordx4 v[160:163], v1, s[44:47], s78 offen offset:0 sc1
    buffer_load_dwordx4 v[164:167], v1, s[44:47], s78 offen offset:1024 sc1
    buffer_load_dwordx4 v[168:171], v1, s[44:47], s79 offen offset:0 sc1
    buffer_load_dwordx4 v[172:175], v1, s[44:47], s79 offen offset:1024 sc1
    buffer_load_dwordx4 v[176:179], v1, s[44:47], s80 offen offset:0 sc1
    buffer_load_dwordx4 v[180:183], v1, s[44:47], s80 offen offset:1024 sc1
    buffer_load_dwordx4 v[184:187], v1, s[44:47], s81 offen offset:0 sc1
    buffer_load_dwordx4 v[188:191], v1, s[44:47], s81 offen offset:1024 sc1
    s_waitcnt vmcnt(0)
    v_xor_b32 v135, v112, v142
    v_bitop3_b32 v135, v135, v113, v142 bitop3:0xf6
    v_bitop3_b32 v135, v135, v114, v142 bitop3:0xf6
    v_bitop3_b32 v135, v135, v115, v142 bitop3:0xf6
    v_bitop3_b32 v135, v135, v116, v142 bitop3:0xf6
    v_bitop3_b32 v135, v135, v117, v142 bitop3:0xf6
    v_bitop3_b32 v135, v135, v118, v142 bitop3:0xf6
    v_bitop3_b32 v135, v135, v119, v142 bitop3:0xf6
    v_bitop3_b32 v135, v135, v120, v142 bitop3:0xf6
    v_bitop3_b32 v135, v135, v121, v142 bitop3:0xf6
    v_bitop3_b32 v135, v135, v122, v142 bitop3:0xf6
    v_bitop3_b32 v135, v135, v123, v142 bitop3:0xf6
    v_bitop3_b32 v135, v135, v124, v142 bitop3:0xf6
    v_bitop3_b32 v135, v135, v125, v142 bitop3:0xf6
    v_bitop3_b32 v135, v135, v126, v142 bitop3:0xf6
    v_bitop3_b32 v135, v135, v127, v142 bitop3:0xf6
    v_and_b32 v135, s96, v135
    v_cmp_ne_u32_e64 vcc, 0, v135
    s_cbranch_vccnz Lfs_2
    s_branch Lfs_2_ret
Lfs_3:
    s_add_u32 s97, s97, 1
    s_cmp_ge_u32 s97, 50000
    s_cbranch_scc1 Lfs_3_ret
    s_nop 0
    buffer_load_dwordx4 v[160:163], v1, s[44:47], s78 offen offset:0 sc1
    buffer_load_dwordx4 v[164:167], v1, s[44:47], s78 offen offset:1024 sc1
    buffer_load_dwordx4 v[168:171], v1, s[44:47], s79 offen offset:0 sc1
    buffer_load_dwordx4 v[172:175], v1, s[44:47], s79 offen offset:1024 sc1
    buffer_load_dwordx4 v[176:179], v1, s[44:47], s80 offen offset:0 sc1
    buffer_load_dwordx4 v[180:183], v1, s[44:47], s80 offen offset:1024 sc1
    buffer_load_dwordx4 v[184:187], v1, s[44:47], s81 offen offset:0 sc1
    buffer_load_dwordx4 v[188:191], v1, s[44:47], s81 offen offset:1024 sc1
    buffer_load_dwordx4 v[192:195], v1, s[44:47], s82 offen offset:0 sc1
    buffer_load_dwordx4 v[196:199], v1, s[44:47], s82 offen offset:1024 sc1
    buffer_load_dwordx4 v[200:203], v1, s[44:47], s83 offen offset:0 sc1
    buffer_load_dwordx4 v[204:207], v1, s[44:47], s83 offen offset:1024 sc1
    s_waitcnt vmcnt(0)
    v_xor_b32 v135, v160, v142
    v_bitop3_b32 v135, v135, v161, v142 bitop3:0xf6
    v_bitop3_b32 v135, v135, v162, v142 bitop3:0xf6
    v_bitop3_b32 v135, v135, v163, v142 bitop3:0xf6
    v_bitop3_b32 v135, v135, v164, v142 bitop3:0xf6
    v_bitop3_b32 v135, v135, v165, v142 bitop3:0xf6
    v_bitop3_b32 v135, v135, v166, v142 bitop3:0xf6
    v_bitop3_b32 v135, v135, v167, v142 bitop3:0xf6
    v_bitop3_b32 v135, v135, v168, v142 bitop3:0xf6
    v_bitop3_b32 v135, v135, v169, v142 bitop3:0xf6
    v_bitop3_b32 v135, v135, v170, v142 bitop3:0xf6
    v_bitop3_b32 v135, v135, v171, v142 bitop3:0xf6
    v_bitop3_b32 v135, v135, v172, v142 bitop3:0xf6
    v_bitop3_b32 v135, v135, v173, v142 bitop3:0xf6
    v_bitop3_b32 v135, v135, v174, v142 bitop3:0xf6
    v_bitop3_b32 v135, v135, v175, v142 bitop3:0xf6
    v_and_b32 v135, s96, v135
    v_cmp_ne_u32_e64 vcc, 0, v135
    s_cbranch_vccnz Lfs_3
    s_branch Lfs_3_ret
Lfs_4:
    s_add_u32 s97, s97, 1
    s_cmp_ge_u32 s97, 50000
    s_cbranch_scc1 Lfs_4_ret
    s_nop 0
    buffer_load_dwordx4 v[176:179], v1, s[44:47], s80 offen offset:0 sc1
    buffer_load_dwordx4 v[180:183], v1, s[44:47], s80 offen offset:1024 sc1
    buffer_load_dwordx4 v[184:187], v1, s[44:47], s81 offen offset:0 sc1
    buffer_load_dwordx4 v[188:191], v1, s[44:47], s81 offen offset:1024 sc1
    buffer_load_dwordx4 v[192:195], v1, s[44:47], s82 offen offset:0 sc1
    buffer_load_dwordx4 v[196:199], v1, s[44:47], s82 offen offset:1024 sc1
    buffer_load_dwordx4 v[200:203], v1, s[44:47], s83 offen offset:0 sc1
    buffer_load_dwordx4 v[204:207], v1, s[44:47], s83 offen offset:1024 sc1
    s_waitcnt vmcnt(0)
    v_xor_b32 v135, v176, v142
    v_bitop3_b32 v135, v135, v177, v142 bitop3:0xf6
    v_bitop3_b32 v135, v135, v178, v142 bitop3:0xf6
    v_bitop3_b32 v135, v135, v179, v142 bitop3:0xf6
    v_bitop3_b32 v135, v135, v180, v142 bitop3:0xf6
    v_bitop3_b32 v135, v135, v181, v142 bitop3:0xf6
    v_bitop3_b32 v135, v135, v182, v142 bitop3:0xf6
    v_bitop3_b32 v135, v135, v183, v142 bitop3:0xf6
    v_bitop3_b32 v135, v135, v184, v142 bitop3:0xf6
    v_bitop3_b32 v135, v135, v185, v142 bitop3:0xf6
    v_bitop3_b32 v135, v135, v186, v142 bitop3:0xf6
    v_bitop3_b32 v135, v135, v187, v142 bitop3:0xf6
    v_bitop3_b32 v135, v135, v188, v142 bitop3:0xf6
    v_bitop3_b32 v135, v135, v189, v142 bitop3:0xf6
    v_bitop3_b32 v135, v135, v190, v142 bitop3:0xf6
    v_bitop3_b32 v135, v135, v191, v142 bitop3:0xf6
    v_and_b32 v135, s96, v135
    v_cmp_ne_u32_e64 vcc, 0, v135
    s_cbranch_vccnz Lfs_4
    s_branch Lfs_4_ret
Lfs_5:
    s_add_u32 s97, s97, 1
    s_cmp_ge_u32 s97, 50000
    s_cbranch_scc1 Lfs_5_ret
    s_nop 0
    buffer_load_dwordx4 v[192:195], v1, s[44:47], s82 offen offset:0 sc1
    buffer_load_dwordx4 v[196:199], v1, s[44:47], s82 offen offset:1024 sc1
    buffer_load_dwordx4 v[200:203], v1, s[44:47], s83 offen offset:0 sc1
    buffer_load_dwordx4 v[204:207], v1, s[44:47], s83 offen offset:1024 sc1
    buffer_load_dwordx4 v[208:211], v1, s[44:47], s84 offen offset:0 sc1
    buffer_load_dwordx4 v[212:215], v1, s[44:47], s84 offen offset:1024 sc1
    buffer_load_dwordx4 v[216:219], v1, s[44:47], s85 offen offset:0 sc1
    buffer_load_dwordx4 v[220:223], v1, s[44:47], s85 offen offset:1024 sc1
    buffer_load_dwordx4 v[224:227], v141, s[44:47], s72 offen offset:0 sc1
    buffer_load_dwordx4 v[228:231], v141, s[44:47], s72 offen offset:1024 sc1
    buffer_load_dwordx4 v[232:235], v141, s[44:47], s73 offen offset:0 sc1
    buffer_load_dwordx4 v[236:239], v141, s[44:47], s73 offen offset:1024 sc1
    s_waitcnt vmcnt(0)
    v_xor_b32 v135, v192, v142
    v_bitop3_b32 v135, v135, v193, v142 bitop3:0xf6
    v_bitop3_b32 v135, v135, v194, v142 bitop3:0xf6
    v_bitop3_b32 v135, v135, v195, v142 bitop3:0xf6
    v_bitop3_b32 v135, v135, v196, v142 bitop3:0xf6
    v_bitop3_b32 v135, v135, v197, v142 bitop3:0xf6
    v_bitop3_b32 v135, v135, v198, v142 bitop3:0xf6
    v_bitop3_b32 v135, v135, v199, v142 bitop3:0xf6
    v_bitop3_b32 v135, v135, v200, v142 bitop3:0xf6
    v_bitop3_b32 v135, v135, v201, v142 bitop3:0xf6
    v_bitop3_b32 v135, v135, v202, v142 bitop3:0xf6
    v_bitop3_b32 v135, v135, v203, v142 bitop3:0xf6
    v_bitop3_b32 v135, v135, v204, v142 bitop3:0xf6
    v_bitop3_b32 v135, v135, v205, v142 bitop3:0xf6
    v_bitop3_b32 v135, v135, v206, v142 bitop3:0xf6
    v_bitop3_b32 v135, v135, v207, v142 bitop3:0xf6
    v_and_b32 v135, s96, v135
    v_cmp_ne_u32_e64 vcc, 0, v135
    s_cbranch_vccnz Lfs_5
    s_branch Lfs_5_ret
Lfs_6:
    s_add_u32 s97, s97, 1
    s_cmp_ge_u32 s97, 50000
    s_cbranch_scc1 Lfs_6_ret
    s_nop 0
    buffer_load_dwordx4 v[208:211], v1, s[44:47], s84 offen offset:0 sc1
    buffer_load_dwordx4 v[212:215], v1, s[44:47], s84 offen offset:1024 sc1
    buffer_load_dwordx4 v[216:219], v1, s[44:47], s85 offen offset:0 sc1
    buffer_load_dwordx4 v[220:223], v1, s[44:47], s85 offen offset:1024 sc1
    buffer_load_dwordx4 v[224:227], v141, s[44:47], s72 offen offset:0 sc1
    buffer_load_dwordx4 v[228:231], v141, s[44:47], s72 offen offset:1024 sc1
    buffer_load_dwordx4 v[232:235], v141, s[44:47], s73 offen offset:0 sc1
    buffer_load_dwordx4 v[236:239], v141, s[44:47], s73 offen offset:1024 sc1
    buffer_load_dwordx4 v[240:243], v141, s[44:47], s74 offen offset:0 sc1
    buffer_load_dwordx4 v[244:247], v141, s[44:47], s74 offen offset:1024 sc1
    buffer_load_dwordx4 v[248:251], v141, s[44:47], s75 offen offset:0 sc1
    buffer_load_dwordx4 v[252:255], v141, s[44:47], s75 offen offset:1024 sc1
    s_waitcnt vmcnt(0)
    v_xor_b32 v135, v208, v142
    v_bitop3_b32 v135, v135, v209, v142 bitop3:0xf6
    v_bitop3_b32 v135, v135, v210, v142 bitop3:0xf6
    v_bitop3_b32 v135, v135, v211, v142 bitop3:0xf6
    v_bitop3_b32 v135, v135, v212, v142 bitop3:0xf6
    v_bitop3_b32 v135, v135, v213, v142 bitop3:0xf6
    v_bitop3_b32 v135, v135, v214, v142 bitop3:0xf6
    v_bitop3_b32 v135, v135, v215, v142 bitop3:0xf6
    v_bitop3_b32 v135, v135, v216, v142 bitop3:0xf6
    v_bitop3_b32 v135, v135, v217, v142 bitop3:0xf6
    v_bitop3_b32 v135, v135, v218, v142 bitop3:0xf6
    v_bitop3_b32 v135, v135, v219, v142 bitop3:0xf6
    v_bitop3_b32 v135, v135, v220, v142 bitop3:0xf6
    v_bitop3_b32 v135, v135, v221, v142 bitop3:0xf6
    v_bitop3_b32 v135, v135, v222, v142 bitop3:0xf6
    v_bitop3_b32 v135, v135, v223, v142 bitop3:0xf6
    v_and_b32 v135, s96, v135
    v_cmp_ne_u32_e64 vcc, 0, v135
    s_cbranch_vccnz Lfs_6
    s_branch Lfs_6_ret
Lfs_7:
    s_add_u32 s97, s97, 1
    s_cmp_ge_u32 s97, 50000
    s_cbranch_scc1 Lfs_7_ret
    s_nop 0
    buffer_load_dwordx4 v[224:227], v141, s[44:47], s72 offen offset:0 sc1
    buffer_load_dwordx4 v[228:231], v141, s[44:47], s72 offen offset:1024 sc1
    buffer_load_dwordx4 v[232:235], v141, s[44:47], s73 offen offset:0 sc1
    buffer_load_dwordx4 v[236:239], v141, s[44:47], s73 offen offset:1024 sc1
    buffer_load_dwordx4 v[240:243], v141, s[44:47], s74 offen offset:0 sc1
    buffer_load_dwordx4 v[244:247], v141, s[44:47], s74 offen offset:1024 sc1
    buffer_load_dwordx4 v[248:251], v141, s[44:47], s75 offen offset:0 sc1
    buffer_load_dwordx4 v[252:255], v141, s[44:47], s75 offen offset:1024 sc1
    buffer_load_dwordx4 v[160:163], v141, s[44:47], s76 offen offset:0 sc1
    buffer_load_dwordx4 v[164:167], v141, s[44:47], s76 offen offset:1024 sc1
    buffer_load_dwordx4 v[168:171], v141, s[44:47], s77 offen offset:0 sc1
    buffer_load_dwordx4 v[172:175], v141, s[44:47], s77 offen offset:1024 sc1
    s_waitcnt vmcnt(0)
    v_xor_b32 v135, v224, v142
    v_bitop3_b32 v135, v135, v225, v142 bitop3:0xf6
    v_bitop3_b32 v135, v135, v226, v142 bitop3:0xf6
    v_bitop3_b32 v135, v135, v227, v142 bitop3:0xf6
    v_bitop3_b32 v135, v135, v228, v142 bitop3:0xf6
    v_bitop3_b32 v135, v135, v229, v142 bitop3:0xf6
    v_bitop3_b32 v135, v135, v230, v142 bitop3:0xf6
    v_bitop3_b32 v135, v135, v231, v142 bitop3:0xf6
    v_bitop3_b32 v135, v135, v232, v142 bitop3:0xf6
    v_bitop3_b32 v135, v135, v233, v142 bitop3:0xf6
    v_bitop3_b32 v135, v135, v234, v142 bitop3:0xf6
    v_bitop3_b32 v135, v135, v235, v142 bitop3:0xf6
    v_bitop3_b32 v135, v135, v236, v142 bitop3:0xf6
    v_bitop3_b32 v135, v135, v237, v142 bitop3:0xf6
    v_bitop3_b32 v135, v135, v238, v142 bitop3:0xf6
    v_bitop3_b32 v135, v135, v239, v142 bitop3:0xf6
    v_and_b32 v135, s96, v135
    v_cmp_ne_u32_e64 vcc, 0, v135
    s_cbranch_vccnz Lfs_7
    s_branch Lfs_7_ret
Lfs_8:
    s_add_u32 s97, s97, 1
    s_cmp_ge_u32 s97, 50000
    s_cbranch_scc1 Lfs_8_ret
    s_nop 0
    buffer_load_dwordx4 v[240:243], v141, s[44:47], s74 offen offset:0 sc1
    buffer_load_dwordx4 v[244:247], v141, s[44:47], s74 offen offset:1024 sc1
    buffer_load_dwordx4 v[248:251], v141, s[44:47], s75 offen offset:0 sc1
    buffer_load_dwordx4 v[252:255], v141, s[44:47], s75 offen offset:1024 sc1
    buffer_load_dwordx4 v[160:163], v141, s[44:47], s76 offen offset:0 sc1
    buffer_load_dwordx4 v[164:167], v141, s[44:47], s76 offen offset:1024 sc1
    buffer_load_dwordx4 v[168:171], v141, s[44:47], s77 offen offset:0 sc1
    buffer_load_dwordx4 v[172:175], v141, s[44:47], s77 offen offset:1024 sc1
    buffer_load_dwordx4 v[176:179], v141, s[44:47], s78 offen offset:0 sc1
    buffer_load_dwordx4 v[180:183], v141, s[44:47], s78 offen offset:1024 sc1
    buffer_load_dwordx4 v[184:187], v141, s[44:47], s79 offen offset:0 sc1
    buffer_load_dwordx4 v[188:191], v141, s[44:47], s79 offen offset:1024 sc1
    s_waitcnt vmcnt(0)
    v_xor_b32 v135, v240, v142
    v_bitop3_b32 v135, v135, v241, v142 bitop3:0xf6
    v_bitop3_b32 v135, v135, v242, v142 bitop3:0xf6
    v_bitop3_b32 v135, v135, v243, v142 bitop3:0xf6
    v_bitop3_b32 v135, v135, v244, v142 bitop3:0xf6
    v_bitop3_b32 v135, v135, v245, v142 bitop3:0xf6
    v_bitop3_b32 v135, v135, v246, v142 bitop3:0xf6
    v_bitop3_b32 v135, v135, v247, v142 bitop3:0xf6
    v_bitop3_b32 v135, v135, v248, v142 bitop3:0xf6
    v_bitop3_b32 v135, v135, v249, v142 bitop3:0xf6
    v_bitop3_b32 v135, v135, v250, v142 bitop3:0xf6
    v_bitop3_b32 v135, v135, v251, v142 bitop3:0xf6
    v_bitop3_b32 v135, v135, v252, v142 bitop3:0xf6
    v_bitop3_b32 v135, v135, v253, v142 bitop3:0xf6
    v_bitop3_b32 v135, v135, v254, v142 bitop3:0xf6
    v_bitop3_b32 v135, v135, v255, v142 bitop3:0xf6
    v_and_b32 v135, s96, v135
    v_cmp_ne_u32_e64 vcc, 0, v135
    s_cbranch_vccnz Lfs_8
    s_branch Lfs_8_ret
Lfs_9:
    s_add_u32 s97, s97, 1
    s_cmp_ge_u32 s97, 50000
    s_cbranch_scc1 Lfs_9_ret
    s_nop 0
    buffer_load_dwordx4 v[160:163], v141, s[44:47], s76 offen offset:0 sc1
    buffer_load_dwordx4 v[164:167], v141, s[44:47], s76 offen offset:1024 sc1
    buffer_load_dwordx4 v[168:171], v141, s[44:47], s77 offen offset:0 sc1
    buffer_load_dwordx4 v[172:175], v141, s[44:47], s77 offen offset:1024 sc1
    buffer_load_dwordx4 v[176:179], v141, s[44:47], s78 offen offset:0 sc1
    buffer_load_dwordx4 v[180:183], v141, s[44:47], s78 offen offset:1024 sc1
    buffer_load_dwordx4 v[184:187], v141, s[44:47], s79 offen offset:0 sc1
    buffer_load_dwordx4 v[188:191], v141, s[44:47], s79 offen offset:1024 sc1
    buffer_load_dwordx4 v[192:195], v141, s[44:47], s80 offen offset:0 sc1
    buffer_load_dwordx4 v[196:199], v141, s[44:47], s80 offen offset:1024 sc1
    buffer_load_dwordx4 v[200:203], v141, s[44:47], s81 offen offset:0 sc1
    buffer_load_dwordx4 v[204:207], v141, s[44:47], s81 offen offset:1024 sc1
    s_waitcnt vmcnt(0)
    v_xor_b32 v135, v160, v142
    v_bitop3_b32 v135, v135, v161, v142 bitop3:0xf6
    v_bitop3_b32 v135, v135, v162, v142 bitop3:0xf6
    v_bitop3_b32 v135, v135, v163, v142 bitop3:0xf6
    v_bitop3_b32 v135, v135, v164, v142 bitop3:0xf6
    v_bitop3_b32 v135, v135, v165, v142 bitop3:0xf6
    v_bitop3_b32 v135, v135, v166, v142 bitop3:0xf6
    v_bitop3_b32 v135, v135, v167, v142 bitop3:0xf6
    v_bitop3_b32 v135, v135, v168, v142 bitop3:0xf6
    v_bitop3_b32 v135, v135, v169, v142 bitop3:0xf6
    v_bitop3_b32 v135, v135, v170, v142 bitop3:0xf6
    v_bitop3_b32 v135, v135, v171, v142 bitop3:0xf6
    v_bitop3_b32 v135, v135, v172, v142 bitop3:0xf6
    v_bitop3_b32 v135, v135, v173, v142 bitop3:0xf6
    v_bitop3_b32 v135, v135, v174, v142 bitop3:0xf6
    v_bitop3_b32 v135, v135, v175, v142 bitop3:0xf6
    v_and_b32 v135, s96, v135
    v_cmp_ne_u32_e64 vcc, 0, v135
    s_cbranch_vccnz Lfs_9
    s_branch Lfs_9_ret
Lfs_10:
    s_add_u32 s97, s97, 1
    s_cmp_ge_u32 s97, 50000
    s_cbranch_scc1 Lfs_10_ret
    s_nop 0
    buffer_load_dwordx4 v[176:179], v141, s[44:47], s78 offen offset:0 sc1
    buffer_load_dwordx4 v[180:183], v141, s[44:47], s78 offen offset:1024 sc1
    buffer_load_dwordx4 v[184:187], v141, s[44:47], s79 offen offset:0 sc1
    buffer_load_dwordx4 v[188:191], v141, s[44:47], s79 offen offset:1024 sc1
    buffer_load_dwordx4 v[192:195], v141, s[44:47], s80 offen offset:0 sc1
    buffer_load_dwordx4 v[196:199], v141, s[44:47], s80 offen offset:1024 sc1
    buffer_load_dwordx4 v[200:203], v141, s[44:47], s81 offen offset:0 sc1
    buffer_load_dwordx4 v[204:207], v141, s[44:47], s81 offen offset:1024 sc1
    buffer_load_dwordx4 v[208:211], v141, s[44:47], s82 offen offset:0 sc1
    buffer_load_dwordx4 v[212:215], v141, s[44:47], s82 offen offset:1024 sc1
    buffer_load_dwordx4 v[216:219], v141, s[44:47], s83 offen offset:0 sc1
    buffer_load_dwordx4 v[220:223], v141, s[44:47], s83 offen offset:1024 sc1
    s_waitcnt vmcnt(0)
    v_xor_b32 v135, v176, v142
    v_bitop3_b32 v135, v135, v177, v142 bitop3:0xf6
    v_bitop3_b32 v135, v135, v178, v142 bitop3:0xf6
    v_bitop3_b32 v135, v135, v179, v142 bitop3:0xf6
    v_bitop3_b32 v135, v135, v180, v142 bitop3:0xf6
    v_bitop3_b32 v135, v135, v181, v142 bitop3:0xf6
    v_bitop3_b32 v135, v135, v182, v142 bitop3:0xf6
    v_bitop3_b32 v135, v135, v183, v142 bitop3:0xf6
    v_bitop3_b32 v135, v135, v184, v142 bitop3:0xf6
    v_bitop3_b32 v135, v135, v185, v142 bitop3:0xf6
    v_bitop3_b32 v135, v135, v186, v142 bitop3:0xf6
    v_bitop3_b32 v135, v135, v187, v142 bitop3:0xf6
    v_bitop3_b32 v135, v135, v188, v142 bitop3:0xf6
    v_bitop3_b32 v135, v135, v189, v142 bitop3:0xf6
    v_bitop3_b32 v135, v135, v190, v142 bitop3:0xf6
    v_bitop3_b32 v135, v135, v191, v142 bitop3:0xf6
    v_and_b32 v135, s96, v135
    v_cmp_ne_u32_e64 vcc, 0, v135
    s_cbranch_vccnz Lfs_10
    s_branch Lfs_10_ret
Lfs_11:
    s_add_u32 s97, s97, 1
    s_cmp_ge_u32 s97, 50000
    s_cbranch_scc1 Lfs_11_ret
    s_nop 0
    buffer_load_dwordx4 v[192:195], v141, s[44:47], s80 offen offset:0 sc1
    buffer_load_dwordx4 v[196:199], v141, s[44:47], s80 offen offset:1024 sc1
    buffer_load_dwordx4 v[200:203], v141, s[44:47], s81 offen offset:0 sc1
    buffer_load_dwordx4 v[204:207], v141, s[44:47], s81 offen offset:1024 sc1
    buffer_load_dwordx4 v[208:211], v141, s[44:47], s82 offen offset:0 sc1
    buffer_load_dwordx4 v[212:215], v141, s[44:47], s82 offen offset:1024 sc1
    buffer_load_dwordx4 v[216:219], v141, s[44:47], s83 offen offset:0 sc1
    buffer_load_dwordx4 v[220:223], v141, s[44:47], s83 offen offset:1024 sc1
    buffer_load_dwordx4 v[224:227], v141, s[44:47], s84 offen offset:0 sc1
    buffer_load_dwordx4 v[228:231], v141, s[44:47], s84 offen offset:1024 sc1
    buffer_load_dwordx4 v[232:235], v141, s[44:47], s85 offen offset:0 sc1
    buffer_load_dwordx4 v[236:239], v141, s[44:47], s85 offen offset:1024 sc1
    s_waitcnt vmcnt(0)
    v_xor_b32 v135, v192, v142
    v_bitop3_b32 v135, v135, v193, v142 bitop3:0xf6
    v_bitop3_b32 v135, v135, v194, v142 bitop3:0xf6
    v_bitop3_b32 v135, v135, v195, v142 bitop3:0xf6
    v_bitop3_b32 v135, v135, v196, v142 bitop3:0xf6
    v_bitop3_b32 v135, v135, v197, v142 bitop3:0xf6
    v_bitop3_b32 v135, v135, v198, v142 bitop3:0xf6
    v_bitop3_b32 v135, v135, v199, v142 bitop3:0xf6
    v_bitop3_b32 v135, v135, v200, v142 bitop3:0xf6
    v_bitop3_b32 v135, v135, v201, v142 bitop3:0xf6
    v_bitop3_b32 v135, v135, v202, v142 bitop3:0xf6
    v_bitop3_b32 v135, v135, v203, v142 bitop3:0xf6
    v_bitop3_b32 v135, v135, v204, v142 bitop3:0xf6
    v_bitop3_b32 v135, v135, v205, v142 bitop3:0xf6
    v_bitop3_b32 v135, v135, v206, v142 bitop3:0xf6
    v_bitop3_b32 v135, v135, v207, v142 bitop3:0xf6
    v_and_b32 v135, s96, v135
    v_cmp_ne_u32_e64 vcc, 0, v135
    s_cbranch_vccnz Lfs_11
    s_branch Lfs_11_ret
Lfs_12:
    s_add_u32 s97, s97, 1
    s_cmp_ge_u32 s97, 50000
    s_cbranch_scc1 Lfs_12_ret
    s_nop 0
    buffer_load_dwordx4 v[208:211], v141, s[44:47], s82 offen offset:0 sc1
    buffer_load_dwordx4 v[212:215], v141, s[44:47], s82 offen offset:1024 sc1
    buffer_load_dwordx4 v[216:219], v141, s[44:47], s83 offen offset:0 sc1
    buffer_load_dwordx4 v[220:223], v141, s[44:47], s83 offen offset:1024 sc1
    buffer_load_dwordx4 v[224:227], v141, s[44:47], s84 offen offset:0 sc1
    buffer_load_dwordx4 v[228:231], v141, s[44:47], s84 offen offset:1024 sc1
    buffer_load_dwordx4 v[232:235], v141, s[44:47], s85 offen offset:0 sc1
    buffer_load_dwordx4 v[236:239], v141, s[44:47], s85 offen offset:1024 sc1
    s_waitcnt vmcnt(0)
    v_xor_b32 v135, v208, v142
    v_bitop3_b32 v135, v135, v209, v142 bitop3:0xf6
    v_bitop3_b32 v135, v135, v210, v142 bitop3:0xf6
    v_bitop3_b32 v135, v135, v211, v142 bitop3:0xf6
    v_bitop3_b32 v135, v135, v212, v142 bitop3:0xf6
    v_bitop3_b32 v135, v135, v213, v142 bitop3:0xf6
    v_bitop3_b32 v135, v135, v214, v142 bitop3:0xf6
    v_bitop3_b32 v135, v135, v215, v142 bitop3:0xf6
    v_bitop3_b32 v135, v135, v216, v142 bitop3:0xf6
    v_bitop3_b32 v135, v135, v217, v142 bitop3:0xf6
    v_bitop3_b32 v135, v135, v218, v142 bitop3:0xf6
    v_bitop3_b32 v135, v135, v219, v142 bitop3:0xf6
    v_bitop3_b32 v135, v135, v220, v142 bitop3:0xf6
    v_bitop3_b32 v135, v135, v221, v142 bitop3:0xf6
    v_bitop3_b32 v135, v135, v222, v142 bitop3:0xf6
    v_bitop3_b32 v135, v135, v223, v142 bitop3:0xf6
    v_and_b32 v135, s96, v135
    v_cmp_ne_u32_e64 vcc, 0, v135
    s_cbranch_vccnz Lfs_12
    s_branch Lfs_12_ret
Lfs_13:
    s_add_u32 s97, s97, 1
    s_cmp_ge_u32 s97, 50000
    s_cbranch_scc1 Lfs_13_ret
    s_nop 0
    buffer_load_dwordx4 v[224:227], v141, s[44:47], s84 offen offset:0 sc1
    buffer_load_dwordx4 v[228:231], v141, s[44:47], s84 offen offset:1024 sc1
    buffer_load_dwordx4 v[232:235], v141, s[44:47], s85 offen offset:0 sc1
    buffer_load_dwordx4 v[236:239], v141, s[44:47], s85 offen offset:1024 sc1
    s_waitcnt vmcnt(0)
    v_xor_b32 v135, v224, v142
    v_bitop3_b32 v135, v135, v225, v142 bitop3:0xf6
    v_bitop3_b32 v135, v135, v226, v142 bitop3:0xf6
    v_bitop3_b32 v135, v135, v227, v142 bitop3:0xf6
    v_bitop3_b32 v135, v135, v228, v142 bitop3:0xf6
    v_bitop3_b32 v135, v135, v229, v142 bitop3:0xf6
    v_bitop3_b32 v135, v135, v230, v142 bitop3:0xf6
    v_bitop3_b32 v135, v135, v231, v142 bitop3:0xf6
    v_bitop3_b32 v135, v135, v232, v142 bitop3:0xf6
    v_bitop3_b32 v135, v135, v233, v142 bitop3:0xf6
    v_bitop3_b32 v135, v135, v234, v142 bitop3:0xf6
    v_bitop3_b32 v135, v135, v235, v142 bitop3:0xf6
    v_bitop3_b32 v135, v135, v236, v142 bitop3:0xf6
    v_bitop3_b32 v135, v135, v237, v142 bitop3:0xf6
    v_bitop3_b32 v135, v135, v238, v142 bitop3:0xf6
    v_bitop3_b32 v135, v135, v239, v142 bitop3:0xf6
    v_and_b32 v135, s96, v135
    v_cmp_ne_u32 vcc, 0, v135
    s_cbranch_vccnz Lfs_13
    s_branch Lfs_13_ret
Lcodeend:

.section .rodata,"a"
.p2align 6
.amdhsa_kernel sequential_preLN__ssm_conv_s4__dense_activation_relu__prompt_kernel
  .amdhsa_next_free_vgpr 512
  .amdhsa_next_free_sgpr 102
  .amdhsa_accum_offset 256
  .amdhsa_group_segment_fixed_size 0
  .amdhsa_kernarg_size 120
  .amdhsa_user_sgpr_count 2
  .amdhsa_user_sgpr_kernarg_segment_ptr 1
  .amdhsa_system_sgpr_workgroup_id_x 1
  .amdhsa_float_denorm_mode_32 3
.end_amdhsa_kernel
```
